```python
import torch

def _softmax(x, axis=-1):
    return torch.softmax(x, dim=axis)
def _gelu(x):
    return torch.nn.functional.gelu(x, approximate="tanh")
def _silu(x):
    return torch.nn.functional.silu(x)
def _sigmoid(x):
    return torch.sigmoid(x)
def _layernorm(x, axis=-1, eps=1e-5):
    m = x.mean(dim=axis, keepdim=True)
    v = x.var(dim=axis, keepdim=True, unbiased=False)
    return (x - m) / torch.sqrt(v + eps)
def _scatter_add(tgt, idx, src, axis=0):
    return tgt.clone().index_add_(axis, idx, src)
def _segment_sum(src, seg, n):
    out = torch.zeros((n,) + src.shape[1:], dtype=src.dtype)
    return out.index_add_(0, seg, src)
def _pad(x, pw):
    flat = tuple(v for pair in reversed(pw) for v in pair)
    return torch.nn.functional.pad(x, flat)

kernel_name = 'concat_heads__grouped_kv_mqa__sliding_local_dilated__prompt'

def setup_inputs():

    _w = (lambda a: (lambda t: t.to(torch.bfloat16) if t.is_floating_point() else t)(torch.as_tensor(a)))
    def _A_setup():
        B, S, D, H = 1, 2048, 448, 16
        Dh = D // H
        return {
            "x": _w((lambda *s: torch.randn(*s, dtype=torch.bfloat16) * 0.05)(B, S, D)),
            "wq": _w((lambda *s: torch.randn(*s, dtype=torch.bfloat16) * 3.2)(D, H * Dh)),
            "wk": _w((lambda *s: torch.randn(*s, dtype=torch.bfloat16) * 3.2)(D, Dh)),
            "wv": _w((lambda *s: torch.randn(*s, dtype=torch.bfloat16) * 1.6)(D, Dh)),
            "wo": _w((lambda *s: torch.randn(*s, dtype=torch.bfloat16) * 1.6)(H * Dh, D)),
        }
    _A_in = _A_setup()

    def _B_setup():
        B, S, D = 1, 2048, 448
        return {
            "x": _w((lambda *s: torch.randn(*s, dtype=torch.bfloat16) * 0.1)(B, S, D)),
            "wqkv": _w((lambda *s: torch.randn(*s, dtype=torch.bfloat16) * 0.8)(D, 3 * D)),
            "wo": _w((lambda *s: torch.randn(*s, dtype=torch.bfloat16) * 0.8)(D, D)),
        }
    _B_in = _B_setup()

    return {
        "A_x": _A_in["x"],
        "A_wq": _A_in["wq"],
        "A_wk": _A_in["wk"],
        "A_wv": _A_in["wv"],
        "A_wo": _A_in["wo"],
        "B_x": _B_in["x"],
        "B_wqkv": _B_in["wqkv"],
        "B_wo": _B_in["wo"],
    }

def reference(A_x, A_wq, A_wk, A_wv, A_wo, B_x, B_wqkv, B_wo):
    def _A_ref(x, wq, wk, wv, wo):
        B, S, D = x.shape
        H = 16
        Dh = D // H
        q = (lambda x, *d: x.permute(*d))((x @ wq).reshape(B, S, H, Dh), 0, 2, 1, 3)
        k = x @ wk
        v = x @ wv
        scores = torch.einsum("bhqd,bkd->bhqk", q, k) * (Dh ** -0.5)
        p = _softmax(scores, axis=-1)
        o = torch.einsum("bhqk,bkd->bhqd", p, v)
        return (lambda x, *d: x.permute(*d))(o, 0, 2, 1, 3).reshape(B, S, H * Dh) @ wo

    def _B_ref(x, wqkv, wo):
        B, S, D = x.shape
        H = 16; Dh = D // H
        W, dil = 8, 2
        qkv = (lambda x, *d: x.permute(*d))((x @ wqkv).reshape(B, S, 3, H, Dh), 2, 0, 3, 1, 4)
        q, k, v = qkv[0], qkv[1], qkv[2]
        scale = Dh ** -0.5
        pos = torch.arange(S)
        off = torch.arange(W) * dil
        idx = pos[:, None] - off[None, :]
        mask = idx >= 0
        idx_c = torch.where(mask, idx, 0).reshape(-1)
        kg = k[:, :, idx_c, :].reshape(B, H, S, W, Dh)
        vg = v[:, :, idx_c, :].reshape(B, H, S, W, Dh)
        logits = torch.einsum("bhsd,bhswd->bhsw", q, kg) * scale
        logits = torch.where(mask[None, None, :, :], logits, -1e9)
        attn = _softmax(logits, axis=-1)
        o = torch.einsum("bhsw,bhswd->bhsd", attn, vg)
        return (lambda x, *d: x.permute(*d))(o, 0, 2, 1, 3).reshape(B, S, D) @ wo

    a = _A_ref(A_x, A_wq, A_wk, A_wv, A_wo)
    b = _B_ref(B_x, B_wqkv, B_wo)
    return torch.concatenate([a, b], axis=-1)
```

```asm
; @launch kernel=k1_kernel grid=(256,1,1) block=(256,1,1) lds=77824
; @launch kernel=k2_kernel grid=(320,1,1) block=(512,1,1) lds=65536
; @launch kernel=k3_kernel grid=(224,1,1) block=(256,1,1) lds=77824
.amdgcn_target "amdgcn-amd-amdhsa--gfx950"
.text
.p2align 8
.globl k1_kernel
.type k1_kernel,@function
k1_kernel:
    s_cmp_ge_u32 s2, 256
    s_cbranch_scc1 K1_END
    s_load_dwordx8 s[4:11], s[0:1], 0
    s_load_dwordx4 s[12:15], s[0:1], 40
    s_load_dwordx2 s[16:17], s[0:1], 80
    s_and_b32 s39, s2, 15
    s_lshr_b32 s3, s2, 4
    s_mul_i32 s32, s39, 114688
    s_lshl_b32 s39, s39, 7
    v_and_b32 v1, 63, v0
    v_lshrrev_b32 v2, 6, v0
    s_nop 0
    v_readfirstlane_b32 s35, v2
    s_and_b32 s36, s35, 1
    s_lshr_b32 s37, s35, 1
    s_waitcnt lgkmcnt(0)
    s_mov_b32 s44, s16
    s_and_b32 s45, s17, 0xffff
    s_mov_b32 s46, 268435456
    s_mov_b32 s47, 0x20000
    s_cmp_ge_u32 s3, 5
    s_cbranch_scc1 K1_B
    s_mov_b32 s24, s4
    s_and_b32 s25, s5, 0xffff
    s_mov_b32 s26, 1835008
    s_mov_b32 s27, 0x20000
    s_cmp_eq_u32 s3, 4
    s_cbranch_scc1 K1_KV
    s_mov_b32 s28, s6
    s_and_b32 s29, s7, 0xffff
    s_mov_b32 s30, 401408
    s_mov_b32 s31, 0x20000
    s_mov_b32 s33, 896
    s_lshl_b32 s34, s3, 8
    v_lshrrev_b32 v12, 3, v0
    v_and_b32 v13, 7, v0
    v_mul_u32_u24 v2, 896, v12
    v_lshl_add_u32 v2, v13, 4, v2
    v_add_u32 v2, s32, v2
    v_add_u32 v3, 28672, v2
    v_add_u32 v4, 57344, v2
    v_add_u32 v5, 86016, v2
    v_mul_u32_u24 v10, 144, v12
    v_lshl_add_u32 v10, v13, 4, v10
    v_lshrrev_b32 v12, 4, v0
    v_and_b32 v13, 15, v0
    v_mul_lo_u32 v6, s33, v12
    v_lshl_add_u32 v6, v13, 4, v6
    v_add_u32 v6, s34, v6
    s_mul_i32 s35, s33, 16
    v_add_u32 v7, s35, v6
    v_add_u32 v8, s35, v7
    v_add_u32 v9, s35, v8
    v_mul_u32_u24 v11, 320, v12
    v_lshl_add_u32 v11, v13, 4, v11
    v_add_u32 v11, 18432, v11
    v_and_b32 v12, 31, v1
    v_lshrrev_b32 v13, 5, v1
    s_lshl_b32 s35, s36, 6
    v_add_u32 v12, s35, v12
    v_mul_u32_u24 v52, 144, v12
    v_lshl_add_u32 v52, v13, 4, v52
    v_bfe_u32 v12, v1, 2, 2
    v_lshl_add_u32 v12, v13, 3, v12
    v_mul_u32_u24 v53, 320, v12
    v_bfe_u32 v12, v1, 4, 1
    v_and_b32 v13, 3, v1
    v_lshlrev_b32 v12, 5, v12
    v_lshl_add_u32 v12, v13, 3, v12
    v_add_u32 v53, v53, v12
    s_mul_i32 s35, s37, 128
    v_add_u32 v53, s35, v53
    v_add_u32 v53, 18432, v53
    v_mov_b32 v64, 0
    v_mov_b32 v65, 0
    v_mov_b32 v66, 0
    v_mov_b32 v67, 0
    v_mov_b32 v68, 0
    v_mov_b32 v69, 0
    v_mov_b32 v70, 0
    v_mov_b32 v71, 0
    v_mov_b32 v72, 0
    v_mov_b32 v73, 0
    v_mov_b32 v74, 0
    v_mov_b32 v75, 0
    v_mov_b32 v76, 0
    v_mov_b32 v77, 0
    v_mov_b32 v78, 0
    v_mov_b32 v79, 0
    v_mov_b32 v80, 0
    v_mov_b32 v81, 0
    v_mov_b32 v82, 0
    v_mov_b32 v83, 0
    v_mov_b32 v84, 0
    v_mov_b32 v85, 0
    v_mov_b32 v86, 0
    v_mov_b32 v87, 0
    v_mov_b32 v88, 0
    v_mov_b32 v89, 0
    v_mov_b32 v90, 0
    v_mov_b32 v91, 0
    v_mov_b32 v92, 0
    v_mov_b32 v93, 0
    v_mov_b32 v94, 0
    v_mov_b32 v95, 0
    v_mov_b32 v96, 0
    v_mov_b32 v97, 0
    v_mov_b32 v98, 0
    v_mov_b32 v99, 0
    v_mov_b32 v100, 0
    v_mov_b32 v101, 0
    v_mov_b32 v102, 0
    v_mov_b32 v103, 0
    v_mov_b32 v104, 0
    v_mov_b32 v105, 0
    v_mov_b32 v106, 0
    v_mov_b32 v107, 0
    v_mov_b32 v108, 0
    v_mov_b32 v109, 0
    v_mov_b32 v110, 0
    v_mov_b32 v111, 0
    v_mov_b32 v112, 0
    v_mov_b32 v113, 0
    v_mov_b32 v114, 0
    v_mov_b32 v115, 0
    v_mov_b32 v116, 0
    v_mov_b32 v117, 0
    v_mov_b32 v118, 0
    v_mov_b32 v119, 0
    v_mov_b32 v120, 0
    v_mov_b32 v121, 0
    v_mov_b32 v122, 0
    v_mov_b32 v123, 0
    v_mov_b32 v124, 0
    v_mov_b32 v125, 0
    v_mov_b32 v126, 0
    v_mov_b32 v127, 0
    s_mov_b32 s38, 0
    buffer_load_dwordx4 v[16:19], v2, s[24:27], s38 offen
    buffer_load_dwordx4 v[20:23], v3, s[24:27], s38 offen
    buffer_load_dwordx4 v[24:27], v4, s[24:27], s38 offen
    buffer_load_dwordx4 v[28:31], v5, s[24:27], s38 offen
    s_mul_i32 s38, s33, 0
    buffer_load_dwordx4 v[32:35], v6, s[28:31], s38 offen
    buffer_load_dwordx4 v[36:39], v7, s[28:31], s38 offen
    buffer_load_dwordx4 v[40:43], v8, s[28:31], s38 offen
    buffer_load_dwordx4 v[44:47], v9, s[28:31], s38 offen
    s_mov_b32 s38, 128
    buffer_load_dwordx4 v[144:147], v2, s[24:27], s38 offen
    buffer_load_dwordx4 v[148:151], v3, s[24:27], s38 offen
    buffer_load_dwordx4 v[152:155], v4, s[24:27], s38 offen
    buffer_load_dwordx4 v[156:159], v5, s[24:27], s38 offen
    s_mul_i32 s38, s33, 64
    buffer_load_dwordx4 v[160:163], v6, s[28:31], s38 offen
    buffer_load_dwordx4 v[164:167], v7, s[28:31], s38 offen
    buffer_load_dwordx4 v[168:171], v8, s[28:31], s38 offen
    buffer_load_dwordx4 v[172:175], v9, s[28:31], s38 offen
    s_waitcnt vmcnt(8)
    ds_write_b128 v10, v[16:19] offset:0
    ds_write_b128 v10, v[20:23] offset:4608
    ds_write_b128 v10, v[24:27] offset:9216
    ds_write_b128 v10, v[28:31] offset:13824
    ds_write_b128 v11, v[32:35] offset:0
    ds_write_b128 v11, v[36:39] offset:5120
    ds_write_b128 v11, v[40:43] offset:10240
    ds_write_b128 v11, v[44:47] offset:15360
    s_waitcnt lgkmcnt(0)
    s_barrier
    s_mov_b32 s38, 256
    buffer_load_dwordx4 v[16:19], v2, s[24:27], s38 offen
    buffer_load_dwordx4 v[20:23], v3, s[24:27], s38 offen
    buffer_load_dwordx4 v[24:27], v4, s[24:27], s38 offen
    buffer_load_dwordx4 v[28:31], v5, s[24:27], s38 offen
    s_mul_i32 s38, s33, 128
    buffer_load_dwordx4 v[32:35], v6, s[28:31], s38 offen
    buffer_load_dwordx4 v[36:39], v7, s[28:31], s38 offen
    buffer_load_dwordx4 v[40:43], v8, s[28:31], s38 offen
    buffer_load_dwordx4 v[44:47], v9, s[28:31], s38 offen
    ds_read_b128 v[128:131], v52 offset:0
    ds_read_b128 v[132:135], v52 offset:4608
    ds_read_b64_tr_b16 v[136:137], v53 offset:0
    ds_read_b64_tr_b16 v[138:139], v53 offset:1280
    ds_read_b64_tr_b16 v[140:141], v53 offset:64
    ds_read_b64_tr_b16 v[142:143], v53 offset:1344
    s_waitcnt lgkmcnt(0)
    v_mfma_f32_32x32x16_bf16 v[64:79], v[136:139], v[128:131], v[64:79]
    v_mfma_f32_32x32x16_bf16 v[80:95], v[136:139], v[132:135], v[80:95]
    v_mfma_f32_32x32x16_bf16 v[96:111], v[140:143], v[128:131], v[96:111]
    v_mfma_f32_32x32x16_bf16 v[112:127], v[140:143], v[132:135], v[112:127]
    ds_read_b128 v[128:131], v52 offset:32
    ds_read_b128 v[132:135], v52 offset:4640
    ds_read_b64_tr_b16 v[136:137], v53 offset:5120
    ds_read_b64_tr_b16 v[138:139], v53 offset:6400
    ds_read_b64_tr_b16 v[140:141], v53 offset:5184
    ds_read_b64_tr_b16 v[142:143], v53 offset:6464
    s_waitcnt lgkmcnt(0)
    v_mfma_f32_32x32x16_bf16 v[64:79], v[136:139], v[128:131], v[64:79]
    v_mfma_f32_32x32x16_bf16 v[80:95], v[136:139], v[132:135], v[80:95]
    v_mfma_f32_32x32x16_bf16 v[96:111], v[140:143], v[128:131], v[96:111]
    v_mfma_f32_32x32x16_bf16 v[112:127], v[140:143], v[132:135], v[112:127]
    ds_read_b128 v[128:131], v52 offset:64
    ds_read_b128 v[132:135], v52 offset:4672
    ds_read_b64_tr_b16 v[136:137], v53 offset:10240
    ds_read_b64_tr_b16 v[138:139], v53 offset:11520
    ds_read_b64_tr_b16 v[140:141], v53 offset:10304
    ds_read_b64_tr_b16 v[142:143], v53 offset:11584
    s_waitcnt lgkmcnt(0)
    v_mfma_f32_32x32x16_bf16 v[64:79], v[136:139], v[128:131], v[64:79]
    v_mfma_f32_32x32x16_bf16 v[80:95], v[136:139], v[132:135], v[80:95]
    v_mfma_f32_32x32x16_bf16 v[96:111], v[140:143], v[128:131], v[96:111]
    v_mfma_f32_32x32x16_bf16 v[112:127], v[140:143], v[132:135], v[112:127]
    ds_read_b128 v[128:131], v52 offset:96
    ds_read_b128 v[132:135], v52 offset:4704
    ds_read_b64_tr_b16 v[136:137], v53 offset:15360
    ds_read_b64_tr_b16 v[138:139], v53 offset:16640
    ds_read_b64_tr_b16 v[140:141], v53 offset:15424
    ds_read_b64_tr_b16 v[142:143], v53 offset:16704
    s_waitcnt lgkmcnt(0)
    v_mfma_f32_32x32x16_bf16 v[64:79], v[136:139], v[128:131], v[64:79]
    v_mfma_f32_32x32x16_bf16 v[80:95], v[136:139], v[132:135], v[80:95]
    v_mfma_f32_32x32x16_bf16 v[96:111], v[140:143], v[128:131], v[96:111]
    v_mfma_f32_32x32x16_bf16 v[112:127], v[140:143], v[132:135], v[112:127]
    s_waitcnt vmcnt(8)
    ds_write_b128 v10, v[144:147] offset:38912
    ds_write_b128 v10, v[148:151] offset:43520
    ds_write_b128 v10, v[152:155] offset:48128
    ds_write_b128 v10, v[156:159] offset:52736
    ds_write_b128 v11, v[160:163] offset:38912
    ds_write_b128 v11, v[164:167] offset:44032
    ds_write_b128 v11, v[168:171] offset:49152
    ds_write_b128 v11, v[172:175] offset:54272
    s_waitcnt lgkmcnt(0)
    s_barrier
    s_mov_b32 s38, 384
    buffer_load_dwordx4 v[144:147], v2, s[24:27], s38 offen
    buffer_load_dwordx4 v[148:151], v3, s[24:27], s38 offen
    buffer_load_dwordx4 v[152:155], v4, s[24:27], s38 offen
    buffer_load_dwordx4 v[156:159], v5, s[24:27], s38 offen
    s_mul_i32 s38, s33, 192
    buffer_load_dwordx4 v[160:163], v6, s[28:31], s38 offen
    buffer_load_dwordx4 v[164:167], v7, s[28:31], s38 offen
    buffer_load_dwordx4 v[168:171], v8, s[28:31], s38 offen
    buffer_load_dwordx4 v[172:175], v9, s[28:31], s38 offen
    ds_read_b128 v[128:131], v52 offset:38912
    ds_read_b128 v[132:135], v52 offset:43520
    ds_read_b64_tr_b16 v[136:137], v53 offset:38912
    ds_read_b64_tr_b16 v[138:139], v53 offset:40192
    ds_read_b64_tr_b16 v[140:141], v53 offset:38976
    ds_read_b64_tr_b16 v[142:143], v53 offset:40256
    s_waitcnt lgkmcnt(0)
    v_mfma_f32_32x32x16_bf16 v[64:79], v[136:139], v[128:131], v[64:79]
    v_mfma_f32_32x32x16_bf16 v[80:95], v[136:139], v[132:135], v[80:95]
    v_mfma_f32_32x32x16_bf16 v[96:111], v[140:143], v[128:131], v[96:111]
    v_mfma_f32_32x32x16_bf16 v[112:127], v[140:143], v[132:135], v[112:127]
    ds_read_b128 v[128:131], v52 offset:38944
    ds_read_b128 v[132:135], v52 offset:43552
    ds_read_b64_tr_b16 v[136:137], v53 offset:44032
    ds_read_b64_tr_b16 v[138:139], v53 offset:45312
    ds_read_b64_tr_b16 v[140:141], v53 offset:44096
    ds_read_b64_tr_b16 v[142:143], v53 offset:45376
    s_waitcnt lgkmcnt(0)
    v_mfma_f32_32x32x16_bf16 v[64:79], v[136:139], v[128:131], v[64:79]
    v_mfma_f32_32x32x16_bf16 v[80:95], v[136:139], v[132:135], v[80:95]
    v_mfma_f32_32x32x16_bf16 v[96:111], v[140:143], v[128:131], v[96:111]
    v_mfma_f32_32x32x16_bf16 v[112:127], v[140:143], v[132:135], v[112:127]
    ds_read_b128 v[128:131], v52 offset:38976
    ds_read_b128 v[132:135], v52 offset:43584
    ds_read_b64_tr_b16 v[136:137], v53 offset:49152
    ds_read_b64_tr_b16 v[138:139], v53 offset:50432
    ds_read_b64_tr_b16 v[140:141], v53 offset:49216
    ds_read_b64_tr_b16 v[142:143], v53 offset:50496
    s_waitcnt lgkmcnt(0)
    v_mfma_f32_32x32x16_bf16 v[64:79], v[136:139], v[128:131], v[64:79]
    v_mfma_f32_32x32x16_bf16 v[80:95], v[136:139], v[132:135], v[80:95]
    v_mfma_f32_32x32x16_bf16 v[96:111], v[140:143], v[128:131], v[96:111]
    v_mfma_f32_32x32x16_bf16 v[112:127], v[140:143], v[132:135], v[112:127]
    ds_read_b128 v[128:131], v52 offset:39008
    ds_read_b128 v[132:135], v52 offset:43616
    ds_read_b64_tr_b16 v[136:137], v53 offset:54272
    ds_read_b64_tr_b16 v[138:139], v53 offset:55552
    ds_read_b64_tr_b16 v[140:141], v53 offset:54336
    ds_read_b64_tr_b16 v[142:143], v53 offset:55616
    s_waitcnt lgkmcnt(0)
    v_mfma_f32_32x32x16_bf16 v[64:79], v[136:139], v[128:131], v[64:79]
    v_mfma_f32_32x32x16_bf16 v[80:95], v[136:139], v[132:135], v[80:95]
    v_mfma_f32_32x32x16_bf16 v[96:111], v[140:143], v[128:131], v[96:111]
    v_mfma_f32_32x32x16_bf16 v[112:127], v[140:143], v[132:135], v[112:127]
    s_waitcnt vmcnt(8)
    ds_write_b128 v10, v[16:19] offset:0
    ds_write_b128 v10, v[20:23] offset:4608
    ds_write_b128 v10, v[24:27] offset:9216
    ds_write_b128 v10, v[28:31] offset:13824
    ds_write_b128 v11, v[32:35] offset:0
    ds_write_b128 v11, v[36:39] offset:5120
    ds_write_b128 v11, v[40:43] offset:10240
    ds_write_b128 v11, v[44:47] offset:15360
    s_waitcnt lgkmcnt(0)
    s_barrier
    s_mov_b32 s38, 512
    buffer_load_dwordx4 v[16:19], v2, s[24:27], s38 offen
    buffer_load_dwordx4 v[20:23], v3, s[24:27], s38 offen
    buffer_load_dwordx4 v[24:27], v4, s[24:27], s38 offen
    buffer_load_dwordx4 v[28:31], v5, s[24:27], s38 offen
    s_mul_i32 s38, s33, 256
    buffer_load_dwordx4 v[32:35], v6, s[28:31], s38 offen
    buffer_load_dwordx4 v[36:39], v7, s[28:31], s38 offen
    buffer_load_dwordx4 v[40:43], v8, s[28:31], s38 offen
    buffer_load_dwordx4 v[44:47], v9, s[28:31], s38 offen
    ds_read_b128 v[128:131], v52 offset:0
    ds_read_b128 v[132:135], v52 offset:4608
    ds_read_b64_tr_b16 v[136:137], v53 offset:0
    ds_read_b64_tr_b16 v[138:139], v53 offset:1280
    ds_read_b64_tr_b16 v[140:141], v53 offset:64
    ds_read_b64_tr_b16 v[142:143], v53 offset:1344
    s_waitcnt lgkmcnt(0)
    v_mfma_f32_32x32x16_bf16 v[64:79], v[136:139], v[128:131], v[64:79]
    v_mfma_f32_32x32x16_bf16 v[80:95], v[136:139], v[132:135], v[80:95]
    v_mfma_f32_32x32x16_bf16 v[96:111], v[140:143], v[128:131], v[96:111]
    v_mfma_f32_32x32x16_bf16 v[112:127], v[140:143], v[132:135], v[112:127]
    ds_read_b128 v[128:131], v52 offset:32
    ds_read_b128 v[132:135], v52 offset:4640
    ds_read_b64_tr_b16 v[136:137], v53 offset:5120
    ds_read_b64_tr_b16 v[138:139], v53 offset:6400
    ds_read_b64_tr_b16 v[140:141], v53 offset:5184
    ds_read_b64_tr_b16 v[142:143], v53 offset:6464
    s_waitcnt lgkmcnt(0)
    v_mfma_f32_32x32x16_bf16 v[64:79], v[136:139], v[128:131], v[64:79]
    v_mfma_f32_32x32x16_bf16 v[80:95], v[136:139], v[132:135], v[80:95]
    v_mfma_f32_32x32x16_bf16 v[96:111], v[140:143], v[128:131], v[96:111]
    v_mfma_f32_32x32x16_bf16 v[112:127], v[140:143], v[132:135], v[112:127]
    ds_read_b128 v[128:131], v52 offset:64
    ds_read_b128 v[132:135], v52 offset:4672
    ds_read_b64_tr_b16 v[136:137], v53 offset:10240
    ds_read_b64_tr_b16 v[138:139], v53 offset:11520
    ds_read_b64_tr_b16 v[140:141], v53 offset:10304
    ds_read_b64_tr_b16 v[142:143], v53 offset:11584
    s_waitcnt lgkmcnt(0)
    v_mfma_f32_32x32x16_bf16 v[64:79], v[136:139], v[128:131], v[64:79]
    v_mfma_f32_32x32x16_bf16 v[80:95], v[136:139], v[132:135], v[80:95]
    v_mfma_f32_32x32x16_bf16 v[96:111], v[140:143], v[128:131], v[96:111]
    v_mfma_f32_32x32x16_bf16 v[112:127], v[140:143], v[132:135], v[112:127]
    ds_read_b128 v[128:131], v52 offset:96
    ds_read_b128 v[132:135], v52 offset:4704
    ds_read_b64_tr_b16 v[136:137], v53 offset:15360
    ds_read_b64_tr_b16 v[138:139], v53 offset:16640
    ds_read_b64_tr_b16 v[140:141], v53 offset:15424
    ds_read_b64_tr_b16 v[142:143], v53 offset:16704
    s_waitcnt lgkmcnt(0)
    v_mfma_f32_32x32x16_bf16 v[64:79], v[136:139], v[128:131], v[64:79]
    v_mfma_f32_32x32x16_bf16 v[80:95], v[136:139], v[132:135], v[80:95]
    v_mfma_f32_32x32x16_bf16 v[96:111], v[140:143], v[128:131], v[96:111]
    v_mfma_f32_32x32x16_bf16 v[112:127], v[140:143], v[132:135], v[112:127]
    s_waitcnt vmcnt(8)
    ds_write_b128 v10, v[144:147] offset:38912
    ds_write_b128 v10, v[148:151] offset:43520
    ds_write_b128 v10, v[152:155] offset:48128
    ds_write_b128 v10, v[156:159] offset:52736
    ds_write_b128 v11, v[160:163] offset:38912
    ds_write_b128 v11, v[164:167] offset:44032
    ds_write_b128 v11, v[168:171] offset:49152
    ds_write_b128 v11, v[172:175] offset:54272
    s_waitcnt lgkmcnt(0)
    s_barrier
    s_mov_b32 s38, 640
    buffer_load_dwordx4 v[144:147], v2, s[24:27], s38 offen
    buffer_load_dwordx4 v[148:151], v3, s[24:27], s38 offen
    buffer_load_dwordx4 v[152:155], v4, s[24:27], s38 offen
    buffer_load_dwordx4 v[156:159], v5, s[24:27], s38 offen
    s_mul_i32 s38, s33, 320
    buffer_load_dwordx4 v[160:163], v6, s[28:31], s38 offen
    buffer_load_dwordx4 v[164:167], v7, s[28:31], s38 offen
    buffer_load_dwordx4 v[168:171], v8, s[28:31], s38 offen
    buffer_load_dwordx4 v[172:175], v9, s[28:31], s38 offen
    ds_read_b128 v[128:131], v52 offset:38912
    ds_read_b128 v[132:135], v52 offset:43520
    ds_read_b64_tr_b16 v[136:137], v53 offset:38912
    ds_read_b64_tr_b16 v[138:139], v53 offset:40192
    ds_read_b64_tr_b16 v[140:141], v53 offset:38976
    ds_read_b64_tr_b16 v[142:143], v53 offset:40256
    s_waitcnt lgkmcnt(0)
    v_mfma_f32_32x32x16_bf16 v[64:79], v[136:139], v[128:131], v[64:79]
    v_mfma_f32_32x32x16_bf16 v[80:95], v[136:139], v[132:135], v[80:95]
    v_mfma_f32_32x32x16_bf16 v[96:111], v[140:143], v[128:131], v[96:111]
    v_mfma_f32_32x32x16_bf16 v[112:127], v[140:143], v[132:135], v[112:127]
    ds_read_b128 v[128:131], v52 offset:38944
    ds_read_b128 v[132:135], v52 offset:43552
    ds_read_b64_tr_b16 v[136:137], v53 offset:44032
    ds_read_b64_tr_b16 v[138:139], v53 offset:45312
    ds_read_b64_tr_b16 v[140:141], v53 offset:44096
    ds_read_b64_tr_b16 v[142:143], v53 offset:45376
    s_waitcnt lgkmcnt(0)
    v_mfma_f32_32x32x16_bf16 v[64:79], v[136:139], v[128:131], v[64:79]
    v_mfma_f32_32x32x16_bf16 v[80:95], v[136:139], v[132:135], v[80:95]
    v_mfma_f32_32x32x16_bf16 v[96:111], v[140:143], v[128:131], v[96:111]
    v_mfma_f32_32x32x16_bf16 v[112:127], v[140:143], v[132:135], v[112:127]
    ds_read_b128 v[128:131], v52 offset:38976
    ds_read_b128 v[132:135], v52 offset:43584
    ds_read_b64_tr_b16 v[136:137], v53 offset:49152
    ds_read_b64_tr_b16 v[138:139], v53 offset:50432
    ds_read_b64_tr_b16 v[140:141], v53 offset:49216
    ds_read_b64_tr_b16 v[142:143], v53 offset:50496
    s_waitcnt lgkmcnt(0)
    v_mfma_f32_32x32x16_bf16 v[64:79], v[136:139], v[128:131], v[64:79]
    v_mfma_f32_32x32x16_bf16 v[80:95], v[136:139], v[132:135], v[80:95]
    v_mfma_f32_32x32x16_bf16 v[96:111], v[140:143], v[128:131], v[96:111]
    v_mfma_f32_32x32x16_bf16 v[112:127], v[140:143], v[132:135], v[112:127]
    ds_read_b128 v[128:131], v52 offset:39008
    ds_read_b128 v[132:135], v52 offset:43616
    ds_read_b64_tr_b16 v[136:137], v53 offset:54272
    ds_read_b64_tr_b16 v[138:139], v53 offset:55552
    ds_read_b64_tr_b16 v[140:141], v53 offset:54336
    ds_read_b64_tr_b16 v[142:143], v53 offset:55616
    s_waitcnt lgkmcnt(0)
    v_mfma_f32_32x32x16_bf16 v[64:79], v[136:139], v[128:131], v[64:79]
    v_mfma_f32_32x32x16_bf16 v[80:95], v[136:139], v[132:135], v[80:95]
    v_mfma_f32_32x32x16_bf16 v[96:111], v[140:143], v[128:131], v[96:111]
    v_mfma_f32_32x32x16_bf16 v[112:127], v[140:143], v[132:135], v[112:127]
    s_waitcnt vmcnt(8)
    ds_write_b128 v10, v[16:19] offset:0
    ds_write_b128 v10, v[20:23] offset:4608
    ds_write_b128 v10, v[24:27] offset:9216
    ds_write_b128 v10, v[28:31] offset:13824
    ds_write_b128 v11, v[32:35] offset:0
    ds_write_b128 v11, v[36:39] offset:5120
    ds_write_b128 v11, v[40:43] offset:10240
    ds_write_b128 v11, v[44:47] offset:15360
    s_waitcnt lgkmcnt(0)
    s_barrier
    s_mov_b32 s38, 768
    buffer_load_dwordx4 v[16:19], v2, s[24:27], s38 offen
    buffer_load_dwordx4 v[20:23], v3, s[24:27], s38 offen
    buffer_load_dwordx4 v[24:27], v4, s[24:27], s38 offen
    buffer_load_dwordx4 v[28:31], v5, s[24:27], s38 offen
    s_mul_i32 s38, s33, 384
    buffer_load_dwordx4 v[32:35], v6, s[28:31], s38 offen
    buffer_load_dwordx4 v[36:39], v7, s[28:31], s38 offen
    buffer_load_dwordx4 v[40:43], v8, s[28:31], s38 offen
    buffer_load_dwordx4 v[44:47], v9, s[28:31], s38 offen
    ds_read_b128 v[128:131], v52 offset:0
    ds_read_b128 v[132:135], v52 offset:4608
    ds_read_b64_tr_b16 v[136:137], v53 offset:0
    ds_read_b64_tr_b16 v[138:139], v53 offset:1280
    ds_read_b64_tr_b16 v[140:141], v53 offset:64
    ds_read_b64_tr_b16 v[142:143], v53 offset:1344
    s_waitcnt lgkmcnt(0)
    v_mfma_f32_32x32x16_bf16 v[64:79], v[136:139], v[128:131], v[64:79]
    v_mfma_f32_32x32x16_bf16 v[80:95], v[136:139], v[132:135], v[80:95]
    v_mfma_f32_32x32x16_bf16 v[96:111], v[140:143], v[128:131], v[96:111]
    v_mfma_f32_32x32x16_bf16 v[112:127], v[140:143], v[132:135], v[112:127]
    ds_read_b128 v[128:131], v52 offset:32
    ds_read_b128 v[132:135], v52 offset:4640
    ds_read_b64_tr_b16 v[136:137], v53 offset:5120
    ds_read_b64_tr_b16 v[138:139], v53 offset:6400
    ds_read_b64_tr_b16 v[140:141], v53 offset:5184
    ds_read_b64_tr_b16 v[142:143], v53 offset:6464
    s_waitcnt lgkmcnt(0)
    v_mfma_f32_32x32x16_bf16 v[64:79], v[136:139], v[128:131], v[64:79]
    v_mfma_f32_32x32x16_bf16 v[80:95], v[136:139], v[132:135], v[80:95]
    v_mfma_f32_32x32x16_bf16 v[96:111], v[140:143], v[128:131], v[96:111]
    v_mfma_f32_32x32x16_bf16 v[112:127], v[140:143], v[132:135], v[112:127]
    ds_read_b128 v[128:131], v52 offset:64
    ds_read_b128 v[132:135], v52 offset:4672
    ds_read_b64_tr_b16 v[136:137], v53 offset:10240
    ds_read_b64_tr_b16 v[138:139], v53 offset:11520
    ds_read_b64_tr_b16 v[140:141], v53 offset:10304
    ds_read_b64_tr_b16 v[142:143], v53 offset:11584
    s_waitcnt lgkmcnt(0)
    v_mfma_f32_32x32x16_bf16 v[64:79], v[136:139], v[128:131], v[64:79]
    v_mfma_f32_32x32x16_bf16 v[80:95], v[136:139], v[132:135], v[80:95]
    v_mfma_f32_32x32x16_bf16 v[96:111], v[140:143], v[128:131], v[96:111]
    v_mfma_f32_32x32x16_bf16 v[112:127], v[140:143], v[132:135], v[112:127]
    ds_read_b128 v[128:131], v52 offset:96
    ds_read_b128 v[132:135], v52 offset:4704
    ds_read_b64_tr_b16 v[136:137], v53 offset:15360
    ds_read_b64_tr_b16 v[138:139], v53 offset:16640
    ds_read_b64_tr_b16 v[140:141], v53 offset:15424
    ds_read_b64_tr_b16 v[142:143], v53 offset:16704
    s_waitcnt lgkmcnt(0)
    v_mfma_f32_32x32x16_bf16 v[64:79], v[136:139], v[128:131], v[64:79]
    v_mfma_f32_32x32x16_bf16 v[80:95], v[136:139], v[132:135], v[80:95]
    v_mfma_f32_32x32x16_bf16 v[96:111], v[140:143], v[128:131], v[96:111]
    v_mfma_f32_32x32x16_bf16 v[112:127], v[140:143], v[132:135], v[112:127]
    s_waitcnt vmcnt(8)
    ds_write_b128 v10, v[144:147] offset:38912
    ds_write_b128 v10, v[148:151] offset:43520
    ds_write_b128 v10, v[152:155] offset:48128
    ds_write_b128 v10, v[156:159] offset:52736
    ds_write_b128 v11, v[160:163] offset:38912
    ds_write_b128 v11, v[164:167] offset:44032
    ds_write_b128 v11, v[168:171] offset:49152
    ds_write_b128 v11, v[172:175] offset:54272
    s_waitcnt lgkmcnt(0)
    s_barrier
    ds_read_b128 v[128:131], v52 offset:38912
    ds_read_b128 v[132:135], v52 offset:43520
    ds_read_b64_tr_b16 v[136:137], v53 offset:38912
    ds_read_b64_tr_b16 v[138:139], v53 offset:40192
    ds_read_b64_tr_b16 v[140:141], v53 offset:38976
    ds_read_b64_tr_b16 v[142:143], v53 offset:40256
    s_waitcnt lgkmcnt(0)
    v_mfma_f32_32x32x16_bf16 v[64:79], v[136:139], v[128:131], v[64:79]
    v_mfma_f32_32x32x16_bf16 v[80:95], v[136:139], v[132:135], v[80:95]
    v_mfma_f32_32x32x16_bf16 v[96:111], v[140:143], v[128:131], v[96:111]
    v_mfma_f32_32x32x16_bf16 v[112:127], v[140:143], v[132:135], v[112:127]
    ds_read_b128 v[128:131], v52 offset:38944
    ds_read_b128 v[132:135], v52 offset:43552
    ds_read_b64_tr_b16 v[136:137], v53 offset:44032
    ds_read_b64_tr_b16 v[138:139], v53 offset:45312
    ds_read_b64_tr_b16 v[140:141], v53 offset:44096
    ds_read_b64_tr_b16 v[142:143], v53 offset:45376
    s_waitcnt lgkmcnt(0)
    v_mfma_f32_32x32x16_bf16 v[64:79], v[136:139], v[128:131], v[64:79]
    v_mfma_f32_32x32x16_bf16 v[80:95], v[136:139], v[132:135], v[80:95]
    v_mfma_f32_32x32x16_bf16 v[96:111], v[140:143], v[128:131], v[96:111]
    v_mfma_f32_32x32x16_bf16 v[112:127], v[140:143], v[132:135], v[112:127]
    ds_read_b128 v[128:131], v52 offset:38976
    ds_read_b128 v[132:135], v52 offset:43584
    ds_read_b64_tr_b16 v[136:137], v53 offset:49152
    ds_read_b64_tr_b16 v[138:139], v53 offset:50432
    ds_read_b64_tr_b16 v[140:141], v53 offset:49216
    ds_read_b64_tr_b16 v[142:143], v53 offset:50496
    s_waitcnt lgkmcnt(0)
    v_mfma_f32_32x32x16_bf16 v[64:79], v[136:139], v[128:131], v[64:79]
    v_mfma_f32_32x32x16_bf16 v[80:95], v[136:139], v[132:135], v[80:95]
    v_mfma_f32_32x32x16_bf16 v[96:111], v[140:143], v[128:131], v[96:111]
    v_mfma_f32_32x32x16_bf16 v[112:127], v[140:143], v[132:135], v[112:127]
    ds_read_b128 v[128:131], v52 offset:39008
    ds_read_b128 v[132:135], v52 offset:43616
    ds_read_b64_tr_b16 v[136:137], v53 offset:54272
    ds_read_b64_tr_b16 v[138:139], v53 offset:55552
    ds_read_b64_tr_b16 v[140:141], v53 offset:54336
    ds_read_b64_tr_b16 v[142:143], v53 offset:55616
    s_waitcnt lgkmcnt(0)
    v_mfma_f32_32x32x16_bf16 v[64:79], v[136:139], v[128:131], v[64:79]
    v_mfma_f32_32x32x16_bf16 v[80:95], v[136:139], v[132:135], v[80:95]
    v_mfma_f32_32x32x16_bf16 v[96:111], v[140:143], v[128:131], v[96:111]
    v_mfma_f32_32x32x16_bf16 v[112:127], v[140:143], v[132:135], v[112:127]
    s_waitcnt vmcnt(0)
    ds_write_b128 v10, v[16:19] offset:0
    ds_write_b128 v10, v[20:23] offset:4608
    ds_write_b128 v10, v[24:27] offset:9216
    ds_write_b128 v10, v[28:31] offset:13824
    ds_write_b128 v11, v[32:35] offset:0
    ds_write_b128 v11, v[36:39] offset:5120
    ds_write_b128 v11, v[40:43] offset:10240
    ds_write_b128 v11, v[44:47] offset:15360
    s_waitcnt lgkmcnt(0)
    s_barrier
    ds_read_b128 v[128:131], v52 offset:0
    ds_read_b128 v[132:135], v52 offset:4608
    ds_read_b64_tr_b16 v[136:137], v53 offset:0
    ds_read_b64_tr_b16 v[138:139], v53 offset:1280
    ds_read_b64_tr_b16 v[140:141], v53 offset:64
    ds_read_b64_tr_b16 v[142:143], v53 offset:1344
    s_waitcnt lgkmcnt(0)
    v_mfma_f32_32x32x16_bf16 v[64:79], v[136:139], v[128:131], v[64:79]
    v_mfma_f32_32x32x16_bf16 v[80:95], v[136:139], v[132:135], v[80:95]
    v_mfma_f32_32x32x16_bf16 v[96:111], v[140:143], v[128:131], v[96:111]
    v_mfma_f32_32x32x16_bf16 v[112:127], v[140:143], v[132:135], v[112:127]
    ds_read_b128 v[128:131], v52 offset:32
    ds_read_b128 v[132:135], v52 offset:4640
    ds_read_b64_tr_b16 v[136:137], v53 offset:5120
    ds_read_b64_tr_b16 v[138:139], v53 offset:6400
    ds_read_b64_tr_b16 v[140:141], v53 offset:5184
    ds_read_b64_tr_b16 v[142:143], v53 offset:6464
    s_waitcnt lgkmcnt(0)
    v_mfma_f32_32x32x16_bf16 v[64:79], v[136:139], v[128:131], v[64:79]
    v_mfma_f32_32x32x16_bf16 v[80:95], v[136:139], v[132:135], v[80:95]
    v_mfma_f32_32x32x16_bf16 v[96:111], v[140:143], v[128:131], v[96:111]
    v_mfma_f32_32x32x16_bf16 v[112:127], v[140:143], v[132:135], v[112:127]
    ds_read_b128 v[128:131], v52 offset:64
    ds_read_b128 v[132:135], v52 offset:4672
    ds_read_b64_tr_b16 v[136:137], v53 offset:10240
    ds_read_b64_tr_b16 v[138:139], v53 offset:11520
    ds_read_b64_tr_b16 v[140:141], v53 offset:10304
    ds_read_b64_tr_b16 v[142:143], v53 offset:11584
    s_waitcnt lgkmcnt(0)
    v_mfma_f32_32x32x16_bf16 v[64:79], v[136:139], v[128:131], v[64:79]
    v_mfma_f32_32x32x16_bf16 v[80:95], v[136:139], v[132:135], v[80:95]
    v_mfma_f32_32x32x16_bf16 v[96:111], v[140:143], v[128:131], v[96:111]
    v_mfma_f32_32x32x16_bf16 v[112:127], v[140:143], v[132:135], v[112:127]
    ds_read_b128 v[128:131], v52 offset:96
    ds_read_b128 v[132:135], v52 offset:4704
    ds_read_b64_tr_b16 v[136:137], v53 offset:15360
    ds_read_b64_tr_b16 v[138:139], v53 offset:16640
    ds_read_b64_tr_b16 v[140:141], v53 offset:15424
    ds_read_b64_tr_b16 v[142:143], v53 offset:16704
    s_waitcnt lgkmcnt(0)
    v_mfma_f32_32x32x16_bf16 v[64:79], v[136:139], v[128:131], v[64:79]
    v_mfma_f32_32x32x16_bf16 v[80:95], v[136:139], v[132:135], v[80:95]
    v_mfma_f32_32x32x16_bf16 v[96:111], v[140:143], v[128:131], v[96:111]
    v_mfma_f32_32x32x16_bf16 v[112:127], v[140:143], v[132:135], v[112:127]
    s_nop 15
    v_and_b32 v2, 31, v1
    s_lshl_b32 s35, s36, 6
    s_add_u32 s35, s35, s39
    v_add_u32 v2, s35, v2
    v_lshrrev_b32 v3, 5, v1
    v_lshlrev_b32 v3, 2, v3
    s_mul_i32 s35, s37, 64
    v_add_u32 v3, s35, v3
    s_lshl_b32 s35, s3, 7
    v_add_u32 v3, s35, v3
    s_mov_b32 s38, 0x3e8b97f6
    v_mov_b32 v10, 0
    v_mov_b32 v11, 0
    v_add_u32 v4, 0, v3
    v_mul_u32_u24 v5, 9363, v4
    v_lshrrev_b32 v5, 18, v5
    v_mul_u32_u24 v6, 28, v5
    v_sub_u32 v6, v4, v6
    v_lshrrev_b32 v7, 2, v5
    v_lshlrev_b32 v7, 11, v7
    v_lshrrev_b32 v12, 3, v6
    v_lshl_add_u32 v7, v12, 9, v7
    v_and_b32 v12, 3, v5
    v_lshl_add_u32 v7, v12, 7, v7
    v_and_b32 v12, 7, v6
    v_lshl_add_u32 v7, v12, 1, v7
    v_add_u32 v13, 0, v2
    v_lshrrev_b32 v14, 3, v13
    v_lshlrev_b32 v14, 13, v14
    v_and_b32 v13, 7, v13
    v_lshl_add_u32 v14, v13, 4, v14
    v_add_u32 v14, v14, v7
    v_mul_f32 v64, s38, v64
    v_mul_f32 v65, s38, v65
    v_mul_f32 v66, s38, v66
    v_mul_f32 v67, s38, v67
    v_cvt_pk_bf16_f32 v8, v64, v65
    v_cvt_pk_bf16_f32 v9, v66, v67
    v_cmp_gt_u32 vcc, 448, v4
    s_and_saveexec_b64 s[48:49], vcc
    v_cmp_eq_u32 vcc, 24, v6
    s_and_saveexec_b64 s[50:51], vcc
    buffer_store_dwordx4 v[8:11], v14, s[44:47], 0 offen
    s_andn2_b64 exec, s[50:51], exec
    buffer_store_dwordx2 v[8:9], v14, s[44:47], 0 offen
    s_mov_b64 exec, s[48:49]
    s_nop 1
    v_add_u32 v13, 32, v2
    v_lshrrev_b32 v14, 3, v13
    v_lshlrev_b32 v14, 13, v14
    v_and_b32 v13, 7, v13
    v_lshl_add_u32 v14, v13, 4, v14
    v_add_u32 v14, v14, v7
    v_mul_f32 v80, s38, v80
    v_mul_f32 v81, s38, v81
    v_mul_f32 v82, s38, v82
    v_mul_f32 v83, s38, v83
    v_cvt_pk_bf16_f32 v8, v80, v81
    v_cvt_pk_bf16_f32 v9, v82, v83
    v_cmp_gt_u32 vcc, 448, v4
    s_and_saveexec_b64 s[48:49], vcc
    v_cmp_eq_u32 vcc, 24, v6
    s_and_saveexec_b64 s[50:51], vcc
    buffer_store_dwordx4 v[8:11], v14, s[44:47], 0 offen
    s_andn2_b64 exec, s[50:51], exec
    buffer_store_dwordx2 v[8:9], v14, s[44:47], 0 offen
    s_mov_b64 exec, s[48:49]
    s_nop 1
    v_add_u32 v4, 8, v3
    v_mul_u32_u24 v5, 9363, v4
    v_lshrrev_b32 v5, 18, v5
    v_mul_u32_u24 v6, 28, v5
    v_sub_u32 v6, v4, v6
    v_lshrrev_b32 v7, 2, v5
    v_lshlrev_b32 v7, 11, v7
    v_lshrrev_b32 v12, 3, v6
    v_lshl_add_u32 v7, v12, 9, v7
    v_and_b32 v12, 3, v5
    v_lshl_add_u32 v7, v12, 7, v7
    v_and_b32 v12, 7, v6
    v_lshl_add_u32 v7, v12, 1, v7
    v_add_u32 v13, 0, v2
    v_lshrrev_b32 v14, 3, v13
    v_lshlrev_b32 v14, 13, v14
    v_and_b32 v13, 7, v13
    v_lshl_add_u32 v14, v13, 4, v14
    v_add_u32 v14, v14, v7
    v_mul_f32 v68, s38, v68
    v_mul_f32 v69, s38, v69
    v_mul_f32 v70, s38, v70
    v_mul_f32 v71, s38, v71
    v_cvt_pk_bf16_f32 v8, v68, v69
    v_cvt_pk_bf16_f32 v9, v70, v71
    v_cmp_gt_u32 vcc, 448, v4
    s_and_saveexec_b64 s[48:49], vcc
    v_cmp_eq_u32 vcc, 24, v6
    s_and_saveexec_b64 s[50:51], vcc
    buffer_store_dwordx4 v[8:11], v14, s[44:47], 0 offen
    s_andn2_b64 exec, s[50:51], exec
    buffer_store_dwordx2 v[8:9], v14, s[44:47], 0 offen
    s_mov_b64 exec, s[48:49]
    s_nop 1
    v_add_u32 v13, 32, v2
    v_lshrrev_b32 v14, 3, v13
    v_lshlrev_b32 v14, 13, v14
    v_and_b32 v13, 7, v13
    v_lshl_add_u32 v14, v13, 4, v14
    v_add_u32 v14, v14, v7
    v_mul_f32 v84, s38, v84
    v_mul_f32 v85, s38, v85
    v_mul_f32 v86, s38, v86
    v_mul_f32 v87, s38, v87
    v_cvt_pk_bf16_f32 v8, v84, v85
    v_cvt_pk_bf16_f32 v9, v86, v87
    v_cmp_gt_u32 vcc, 448, v4
    s_and_saveexec_b64 s[48:49], vcc
    v_cmp_eq_u32 vcc, 24, v6
    s_and_saveexec_b64 s[50:51], vcc
    buffer_store_dwordx4 v[8:11], v14, s[44:47], 0 offen
    s_andn2_b64 exec, s[50:51], exec
    buffer_store_dwordx2 v[8:9], v14, s[44:47], 0 offen
    s_mov_b64 exec, s[48:49]
    s_nop 1
    v_add_u32 v4, 16, v3
    v_mul_u32_u24 v5, 9363, v4
    v_lshrrev_b32 v5, 18, v5
    v_mul_u32_u24 v6, 28, v5
    v_sub_u32 v6, v4, v6
    v_lshrrev_b32 v7, 2, v5
    v_lshlrev_b32 v7, 11, v7
    v_lshrrev_b32 v12, 3, v6
    v_lshl_add_u32 v7, v12, 9, v7
    v_and_b32 v12, 3, v5
    v_lshl_add_u32 v7, v12, 7, v7
    v_and_b32 v12, 7, v6
    v_lshl_add_u32 v7, v12, 1, v7
    v_add_u32 v13, 0, v2
    v_lshrrev_b32 v14, 3, v13
    v_lshlrev_b32 v14, 13, v14
    v_and_b32 v13, 7, v13
    v_lshl_add_u32 v14, v13, 4, v14
    v_add_u32 v14, v14, v7
    v_mul_f32 v72, s38, v72
    v_mul_f32 v73, s38, v73
    v_mul_f32 v74, s38, v74
    v_mul_f32 v75, s38, v75
    v_cvt_pk_bf16_f32 v8, v72, v73
    v_cvt_pk_bf16_f32 v9, v74, v75
    v_cmp_gt_u32 vcc, 448, v4
    s_and_saveexec_b64 s[48:49], vcc
    v_cmp_eq_u32 vcc, 24, v6
    s_and_saveexec_b64 s[50:51], vcc
    buffer_store_dwordx4 v[8:11], v14, s[44:47], 0 offen
    s_andn2_b64 exec, s[50:51], exec
    buffer_store_dwordx2 v[8:9], v14, s[44:47], 0 offen
    s_mov_b64 exec, s[48:49]
    s_nop 1
    v_add_u32 v13, 32, v2
    v_lshrrev_b32 v14, 3, v13
    v_lshlrev_b32 v14, 13, v14
    v_and_b32 v13, 7, v13
    v_lshl_add_u32 v14, v13, 4, v14
    v_add_u32 v14, v14, v7
    v_mul_f32 v88, s38, v88
    v_mul_f32 v89, s38, v89
    v_mul_f32 v90, s38, v90
    v_mul_f32 v91, s38, v91
    v_cvt_pk_bf16_f32 v8, v88, v89
    v_cvt_pk_bf16_f32 v9, v90, v91
    v_cmp_gt_u32 vcc, 448, v4
    s_and_saveexec_b64 s[48:49], vcc
    v_cmp_eq_u32 vcc, 24, v6
    s_and_saveexec_b64 s[50:51], vcc
    buffer_store_dwordx4 v[8:11], v14, s[44:47], 0 offen
    s_andn2_b64 exec, s[50:51], exec
    buffer_store_dwordx2 v[8:9], v14, s[44:47], 0 offen
    s_mov_b64 exec, s[48:49]
    s_nop 1
    v_add_u32 v4, 24, v3
    v_mul_u32_u24 v5, 9363, v4
    v_lshrrev_b32 v5, 18, v5
    v_mul_u32_u24 v6, 28, v5
    v_sub_u32 v6, v4, v6
    v_lshrrev_b32 v7, 2, v5
    v_lshlrev_b32 v7, 11, v7
    v_lshrrev_b32 v12, 3, v6
    v_lshl_add_u32 v7, v12, 9, v7
    v_and_b32 v12, 3, v5
    v_lshl_add_u32 v7, v12, 7, v7
    v_and_b32 v12, 7, v6
    v_lshl_add_u32 v7, v12, 1, v7
    v_add_u32 v13, 0, v2
    v_lshrrev_b32 v14, 3, v13
    v_lshlrev_b32 v14, 13, v14
    v_and_b32 v13, 7, v13
    v_lshl_add_u32 v14, v13, 4, v14
    v_add_u32 v14, v14, v7
    v_mul_f32 v76, s38, v76
    v_mul_f32 v77, s38, v77
    v_mul_f32 v78, s38, v78
    v_mul_f32 v79, s38, v79
    v_cvt_pk_bf16_f32 v8, v76, v77
    v_cvt_pk_bf16_f32 v9, v78, v79
    v_cmp_gt_u32 vcc, 448, v4
    s_and_saveexec_b64 s[48:49], vcc
    v_cmp_eq_u32 vcc, 24, v6
    s_and_saveexec_b64 s[50:51], vcc
    buffer_store_dwordx4 v[8:11], v14, s[44:47], 0 offen
    s_andn2_b64 exec, s[50:51], exec
    buffer_store_dwordx2 v[8:9], v14, s[44:47], 0 offen
    s_mov_b64 exec, s[48:49]
    s_nop 1
    v_add_u32 v13, 32, v2
    v_lshrrev_b32 v14, 3, v13
    v_lshlrev_b32 v14, 13, v14
    v_and_b32 v13, 7, v13
    v_lshl_add_u32 v14, v13, 4, v14
    v_add_u32 v14, v14, v7
    v_mul_f32 v92, s38, v92
    v_mul_f32 v93, s38, v93
    v_mul_f32 v94, s38, v94
    v_mul_f32 v95, s38, v95
    v_cvt_pk_bf16_f32 v8, v92, v93
    v_cvt_pk_bf16_f32 v9, v94, v95
    v_cmp_gt_u32 vcc, 448, v4
    s_and_saveexec_b64 s[48:49], vcc
    v_cmp_eq_u32 vcc, 24, v6
    s_and_saveexec_b64 s[50:51], vcc
    buffer_store_dwordx4 v[8:11], v14, s[44:47], 0 offen
    s_andn2_b64 exec, s[50:51], exec
    buffer_store_dwordx2 v[8:9], v14, s[44:47], 0 offen
    s_mov_b64 exec, s[48:49]
    s_nop 1
    v_add_u32 v4, 32, v3
    v_mul_u32_u24 v5, 9363, v4
    v_lshrrev_b32 v5, 18, v5
    v_mul_u32_u24 v6, 28, v5
    v_sub_u32 v6, v4, v6
    v_lshrrev_b32 v7, 2, v5
    v_lshlrev_b32 v7, 11, v7
    v_lshrrev_b32 v12, 3, v6
    v_lshl_add_u32 v7, v12, 9, v7
    v_and_b32 v12, 3, v5
    v_lshl_add_u32 v7, v12, 7, v7
    v_and_b32 v12, 7, v6
    v_lshl_add_u32 v7, v12, 1, v7
    v_add_u32 v13, 0, v2
    v_lshrrev_b32 v14, 3, v13
    v_lshlrev_b32 v14, 13, v14
    v_and_b32 v13, 7, v13
    v_lshl_add_u32 v14, v13, 4, v14
    v_add_u32 v14, v14, v7
    v_mul_f32 v96, s38, v96
    v_mul_f32 v97, s38, v97
    v_mul_f32 v98, s38, v98
    v_mul_f32 v99, s38, v99
    v_cvt_pk_bf16_f32 v8, v96, v97
    v_cvt_pk_bf16_f32 v9, v98, v99
    v_cmp_gt_u32 vcc, 448, v4
    s_and_saveexec_b64 s[48:49], vcc
    v_cmp_eq_u32 vcc, 24, v6
    s_and_saveexec_b64 s[50:51], vcc
    buffer_store_dwordx4 v[8:11], v14, s[44:47], 0 offen
    s_andn2_b64 exec, s[50:51], exec
    buffer_store_dwordx2 v[8:9], v14, s[44:47], 0 offen
    s_mov_b64 exec, s[48:49]
    s_nop 1
    v_add_u32 v13, 32, v2
    v_lshrrev_b32 v14, 3, v13
    v_lshlrev_b32 v14, 13, v14
    v_and_b32 v13, 7, v13
    v_lshl_add_u32 v14, v13, 4, v14
    v_add_u32 v14, v14, v7
    v_mul_f32 v112, s38, v112
    v_mul_f32 v113, s38, v113
    v_mul_f32 v114, s38, v114
    v_mul_f32 v115, s38, v115
    v_cvt_pk_bf16_f32 v8, v112, v113
    v_cvt_pk_bf16_f32 v9, v114, v115
    v_cmp_gt_u32 vcc, 448, v4
    s_and_saveexec_b64 s[48:49], vcc
    v_cmp_eq_u32 vcc, 24, v6
    s_and_saveexec_b64 s[50:51], vcc
    buffer_store_dwordx4 v[8:11], v14, s[44:47], 0 offen
    s_andn2_b64 exec, s[50:51], exec
    buffer_store_dwordx2 v[8:9], v14, s[44:47], 0 offen
    s_mov_b64 exec, s[48:49]
    s_nop 1
    v_add_u32 v4, 40, v3
    v_mul_u32_u24 v5, 9363, v4
    v_lshrrev_b32 v5, 18, v5
    v_mul_u32_u24 v6, 28, v5
    v_sub_u32 v6, v4, v6
    v_lshrrev_b32 v7, 2, v5
    v_lshlrev_b32 v7, 11, v7
    v_lshrrev_b32 v12, 3, v6
    v_lshl_add_u32 v7, v12, 9, v7
    v_and_b32 v12, 3, v5
    v_lshl_add_u32 v7, v12, 7, v7
    v_and_b32 v12, 7, v6
    v_lshl_add_u32 v7, v12, 1, v7
    v_add_u32 v13, 0, v2
    v_lshrrev_b32 v14, 3, v13
    v_lshlrev_b32 v14, 13, v14
    v_and_b32 v13, 7, v13
    v_lshl_add_u32 v14, v13, 4, v14
    v_add_u32 v14, v14, v7
    v_mul_f32 v100, s38, v100
    v_mul_f32 v101, s38, v101
    v_mul_f32 v102, s38, v102
    v_mul_f32 v103, s38, v103
    v_cvt_pk_bf16_f32 v8, v100, v101
    v_cvt_pk_bf16_f32 v9, v102, v103
    v_cmp_gt_u32 vcc, 448, v4
    s_and_saveexec_b64 s[48:49], vcc
    v_cmp_eq_u32 vcc, 24, v6
    s_and_saveexec_b64 s[50:51], vcc
    buffer_store_dwordx4 v[8:11], v14, s[44:47], 0 offen
    s_andn2_b64 exec, s[50:51], exec
    buffer_store_dwordx2 v[8:9], v14, s[44:47], 0 offen
    s_mov_b64 exec, s[48:49]
    s_nop 1
    v_add_u32 v13, 32, v2
    v_lshrrev_b32 v14, 3, v13
    v_lshlrev_b32 v14, 13, v14
    v_and_b32 v13, 7, v13
    v_lshl_add_u32 v14, v13, 4, v14
    v_add_u32 v14, v14, v7
    v_mul_f32 v116, s38, v116
    v_mul_f32 v117, s38, v117
    v_mul_f32 v118, s38, v118
    v_mul_f32 v119, s38, v119
    v_cvt_pk_bf16_f32 v8, v116, v117
    v_cvt_pk_bf16_f32 v9, v118, v119
    v_cmp_gt_u32 vcc, 448, v4
    s_and_saveexec_b64 s[48:49], vcc
    v_cmp_eq_u32 vcc, 24, v6
    s_and_saveexec_b64 s[50:51], vcc
    buffer_store_dwordx4 v[8:11], v14, s[44:47], 0 offen
    s_andn2_b64 exec, s[50:51], exec
    buffer_store_dwordx2 v[8:9], v14, s[44:47], 0 offen
    s_mov_b64 exec, s[48:49]
    s_nop 1
    v_add_u32 v4, 48, v3
    v_mul_u32_u24 v5, 9363, v4
    v_lshrrev_b32 v5, 18, v5
    v_mul_u32_u24 v6, 28, v5
    v_sub_u32 v6, v4, v6
    v_lshrrev_b32 v7, 2, v5
    v_lshlrev_b32 v7, 11, v7
    v_lshrrev_b32 v12, 3, v6
    v_lshl_add_u32 v7, v12, 9, v7
    v_and_b32 v12, 3, v5
    v_lshl_add_u32 v7, v12, 7, v7
    v_and_b32 v12, 7, v6
    v_lshl_add_u32 v7, v12, 1, v7
    v_add_u32 v13, 0, v2
    v_lshrrev_b32 v14, 3, v13
    v_lshlrev_b32 v14, 13, v14
    v_and_b32 v13, 7, v13
    v_lshl_add_u32 v14, v13, 4, v14
    v_add_u32 v14, v14, v7
    v_mul_f32 v104, s38, v104
    v_mul_f32 v105, s38, v105
    v_mul_f32 v106, s38, v106
    v_mul_f32 v107, s38, v107
    v_cvt_pk_bf16_f32 v8, v104, v105
    v_cvt_pk_bf16_f32 v9, v106, v107
    v_cmp_gt_u32 vcc, 448, v4
    s_and_saveexec_b64 s[48:49], vcc
    v_cmp_eq_u32 vcc, 24, v6
    s_and_saveexec_b64 s[50:51], vcc
    buffer_store_dwordx4 v[8:11], v14, s[44:47], 0 offen
    s_andn2_b64 exec, s[50:51], exec
    buffer_store_dwordx2 v[8:9], v14, s[44:47], 0 offen
    s_mov_b64 exec, s[48:49]
    s_nop 1
    v_add_u32 v13, 32, v2
    v_lshrrev_b32 v14, 3, v13
    v_lshlrev_b32 v14, 13, v14
    v_and_b32 v13, 7, v13
    v_lshl_add_u32 v14, v13, 4, v14
    v_add_u32 v14, v14, v7
    v_mul_f32 v120, s38, v120
    v_mul_f32 v121, s38, v121
    v_mul_f32 v122, s38, v122
    v_mul_f32 v123, s38, v123
    v_cvt_pk_bf16_f32 v8, v120, v121
    v_cvt_pk_bf16_f32 v9, v122, v123
    v_cmp_gt_u32 vcc, 448, v4
    s_and_saveexec_b64 s[48:49], vcc
    v_cmp_eq_u32 vcc, 24, v6
    s_and_saveexec_b64 s[50:51], vcc
    buffer_store_dwordx4 v[8:11], v14, s[44:47], 0 offen
    s_andn2_b64 exec, s[50:51], exec
    buffer_store_dwordx2 v[8:9], v14, s[44:47], 0 offen
    s_mov_b64 exec, s[48:49]
    s_nop 1
    v_add_u32 v4, 56, v3
    v_mul_u32_u24 v5, 9363, v4
    v_lshrrev_b32 v5, 18, v5
    v_mul_u32_u24 v6, 28, v5
    v_sub_u32 v6, v4, v6
    v_lshrrev_b32 v7, 2, v5
    v_lshlrev_b32 v7, 11, v7
    v_lshrrev_b32 v12, 3, v6
    v_lshl_add_u32 v7, v12, 9, v7
    v_and_b32 v12, 3, v5
    v_lshl_add_u32 v7, v12, 7, v7
    v_and_b32 v12, 7, v6
    v_lshl_add_u32 v7, v12, 1, v7
    v_add_u32 v13, 0, v2
    v_lshrrev_b32 v14, 3, v13
    v_lshlrev_b32 v14, 13, v14
    v_and_b32 v13, 7, v13
    v_lshl_add_u32 v14, v13, 4, v14
    v_add_u32 v14, v14, v7
    v_mul_f32 v108, s38, v108
    v_mul_f32 v109, s38, v109
    v_mul_f32 v110, s38, v110
    v_mul_f32 v111, s38, v111
    v_cvt_pk_bf16_f32 v8, v108, v109
    v_cvt_pk_bf16_f32 v9, v110, v111
    v_cmp_gt_u32 vcc, 448, v4
    s_and_saveexec_b64 s[48:49], vcc
    v_cmp_eq_u32 vcc, 24, v6
    s_and_saveexec_b64 s[50:51], vcc
    buffer_store_dwordx4 v[8:11], v14, s[44:47], 0 offen
    s_andn2_b64 exec, s[50:51], exec
    buffer_store_dwordx2 v[8:9], v14, s[44:47], 0 offen
    s_mov_b64 exec, s[48:49]
    s_nop 1
    v_add_u32 v13, 32, v2
    v_lshrrev_b32 v14, 3, v13
    v_lshlrev_b32 v14, 13, v14
    v_and_b32 v13, 7, v13
    v_lshl_add_u32 v14, v13, 4, v14
    v_add_u32 v14, v14, v7
    v_mul_f32 v124, s38, v124
    v_mul_f32 v125, s38, v125
    v_mul_f32 v126, s38, v126
    v_mul_f32 v127, s38, v127
    v_cvt_pk_bf16_f32 v8, v124, v125
    v_cvt_pk_bf16_f32 v9, v126, v127
    v_cmp_gt_u32 vcc, 448, v4
    s_and_saveexec_b64 s[48:49], vcc
    v_cmp_eq_u32 vcc, 24, v6
    s_and_saveexec_b64 s[50:51], vcc
    buffer_store_dwordx4 v[8:11], v14, s[44:47], 0 offen
    s_andn2_b64 exec, s[50:51], exec
    buffer_store_dwordx2 v[8:9], v14, s[44:47], 0 offen
    s_mov_b64 exec, s[48:49]
    s_nop 1
    s_endpgm
K1_KV:
    s_mov_b32 s28, s8
    s_and_b32 s29, s9, 0xffff
    s_mov_b32 s30, 25088
    s_mov_b32 s31, 0x20000
    s_mov_b32 s40, s10
    s_and_b32 s41, s11, 0xffff
    s_mov_b32 s42, 25088
    s_mov_b32 s43, 0x20000
    v_lshrrev_b32 v12, 3, v0
    v_and_b32 v13, 7, v0
    v_mul_u32_u24 v2, 896, v12
    v_lshl_add_u32 v2, v13, 4, v2
    v_add_u32 v2, s32, v2
    v_add_u32 v3, 28672, v2
    v_add_u32 v4, 57344, v2
    v_add_u32 v5, 86016, v2
    v_mul_u32_u24 v10, 144, v12
    v_lshl_add_u32 v10, v13, 4, v10
    v_add_u32 v12, 0, v0
    v_mul_u32_u24 v13, 4682, v12
    v_lshrrev_b32 v13, 16, v13
    v_mul_u32_u24 v14, 14, v13
    v_sub_u32 v14, v12, v14
    v_cmp_gt_u32 vcc, 7, v14
    v_subrev_u32 v15, 7, v14
    s_nop 1
    v_cndmask_b32 v15, v15, v14, vcc
    v_mul_u32_u24 v6, 56, v13
    v_lshl_add_u32 v6, v15, 3, v6
    v_mov_b32 v16, 64
    v_cndmask_b32 v16, v16, 0, vcc
    v_mul_u32_u24 v44, 320, v13
    v_lshl_add_u32 v44, v15, 3, v44
    v_add_u32 v44, v44, v16
    v_add_u32 v44, 18432, v44
    v_cndmask_b32 v48, 0, 1, vcc
    v_cmp_lt_u32 vcc, 63, v13
    v_mov_b32 v16, 0x7fffff00
    s_nop 0
    v_cndmask_b32 v6, v6, v16, vcc
    v_mov_b32 v16, 38848
    v_cndmask_b32 v44, v44, v16, vcc
    v_add_u32 v12, 256, v0
    v_mul_u32_u24 v13, 4682, v12
    v_lshrrev_b32 v13, 16, v13
    v_mul_u32_u24 v14, 14, v13
    v_sub_u32 v14, v12, v14
    v_cmp_gt_u32 vcc, 7, v14
    v_subrev_u32 v15, 7, v14
    s_nop 1
    v_cndmask_b32 v15, v15, v14, vcc
    v_mul_u32_u24 v7, 56, v13
    v_lshl_add_u32 v7, v15, 3, v7
    v_mov_b32 v16, 64
    v_cndmask_b32 v16, v16, 0, vcc
    v_mul_u32_u24 v45, 320, v13
    v_lshl_add_u32 v45, v15, 3, v45
    v_add_u32 v45, v45, v16
    v_add_u32 v45, 18432, v45
    v_cndmask_b32 v49, 0, 1, vcc
    v_cmp_lt_u32 vcc, 63, v13
    v_mov_b32 v16, 0x7fffff00
    s_nop 0
    v_cndmask_b32 v7, v7, v16, vcc
    v_mov_b32 v16, 38848
    v_cndmask_b32 v45, v45, v16, vcc
    v_add_u32 v12, 512, v0
    v_mul_u32_u24 v13, 4682, v12
    v_lshrrev_b32 v13, 16, v13
    v_mul_u32_u24 v14, 14, v13
    v_sub_u32 v14, v12, v14
    v_cmp_gt_u32 vcc, 7, v14
    v_subrev_u32 v15, 7, v14
    s_nop 1
    v_cndmask_b32 v15, v15, v14, vcc
    v_mul_u32_u24 v8, 56, v13
    v_lshl_add_u32 v8, v15, 3, v8
    v_mov_b32 v16, 64
    v_cndmask_b32 v16, v16, 0, vcc
    v_mul_u32_u24 v46, 320, v13
    v_lshl_add_u32 v46, v15, 3, v46
    v_add_u32 v46, v46, v16
    v_add_u32 v46, 18432, v46
    v_cndmask_b32 v50, 0, 1, vcc
    v_cmp_lt_u32 vcc, 63, v13
    v_mov_b32 v16, 0x7fffff00
    s_nop 0
    v_cndmask_b32 v8, v8, v16, vcc
    v_mov_b32 v16, 38848
    v_cndmask_b32 v46, v46, v16, vcc
    v_add_u32 v12, 768, v0
    v_mul_u32_u24 v13, 4682, v12
    v_lshrrev_b32 v13, 16, v13
    v_mul_u32_u24 v14, 14, v13
    v_sub_u32 v14, v12, v14
    v_cmp_gt_u32 vcc, 7, v14
    v_subrev_u32 v15, 7, v14
    s_nop 1
    v_cndmask_b32 v15, v15, v14, vcc
    v_mul_u32_u24 v9, 56, v13
    v_lshl_add_u32 v9, v15, 3, v9
    v_mov_b32 v16, 64
    v_cndmask_b32 v16, v16, 0, vcc
    v_mul_u32_u24 v47, 320, v13
    v_lshl_add_u32 v47, v15, 3, v47
    v_add_u32 v47, v47, v16
    v_add_u32 v47, 18432, v47
    v_cndmask_b32 v51, 0, 1, vcc
    v_cmp_lt_u32 vcc, 63, v13
    v_mov_b32 v16, 0x7fffff00
    s_nop 0
    v_cndmask_b32 v9, v9, v16, vcc
    v_mov_b32 v16, 38848
    v_cndmask_b32 v47, v47, v16, vcc
    v_and_b32 v12, 31, v1
    v_lshrrev_b32 v13, 5, v1
    s_lshl_b32 s35, s36, 6
    v_add_u32 v12, s35, v12
    v_mul_u32_u24 v52, 144, v12
    v_lshl_add_u32 v52, v13, 4, v52
    v_bfe_u32 v12, v1, 2, 2
    v_lshl_add_u32 v12, v13, 3, v12
    v_mul_u32_u24 v53, 320, v12
    v_bfe_u32 v12, v1, 4, 1
    v_and_b32 v13, 3, v1
    v_lshlrev_b32 v12, 5, v12
    v_lshl_add_u32 v12, v13, 3, v12
    v_add_u32 v53, v53, v12
    s_mul_i32 s35, s37, 128
    v_add_u32 v53, s35, v53
    v_add_u32 v53, 18432, v53
    v_mov_b32 v64, 0
    v_mov_b32 v65, 0
    v_mov_b32 v66, 0
    v_mov_b32 v67, 0
    v_mov_b32 v68, 0
    v_mov_b32 v69, 0
    v_mov_b32 v70, 0
    v_mov_b32 v71, 0
    v_mov_b32 v72, 0
    v_mov_b32 v73, 0
    v_mov_b32 v74, 0
    v_mov_b32 v75, 0
    v_mov_b32 v76, 0
    v_mov_b32 v77, 0
    v_mov_b32 v78, 0
    v_mov_b32 v79, 0
    v_mov_b32 v80, 0
    v_mov_b32 v81, 0
    v_mov_b32 v82, 0
    v_mov_b32 v83, 0
    v_mov_b32 v84, 0
    v_mov_b32 v85, 0
    v_mov_b32 v86, 0
    v_mov_b32 v87, 0
    v_mov_b32 v88, 0
    v_mov_b32 v89, 0
    v_mov_b32 v90, 0
    v_mov_b32 v91, 0
    v_mov_b32 v92, 0
    v_mov_b32 v93, 0
    v_mov_b32 v94, 0
    v_mov_b32 v95, 0
    v_mov_b32 v96, 0
    v_mov_b32 v97, 0
    v_mov_b32 v98, 0
    v_mov_b32 v99, 0
    v_mov_b32 v100, 0
    v_mov_b32 v101, 0
    v_mov_b32 v102, 0
    v_mov_b32 v103, 0
    v_mov_b32 v104, 0
    v_mov_b32 v105, 0
    v_mov_b32 v106, 0
    v_mov_b32 v107, 0
    v_mov_b32 v108, 0
    v_mov_b32 v109, 0
    v_mov_b32 v110, 0
    v_mov_b32 v111, 0
    v_mov_b32 v112, 0
    v_mov_b32 v113, 0
    v_mov_b32 v114, 0
    v_mov_b32 v115, 0
    v_mov_b32 v116, 0
    v_mov_b32 v117, 0
    v_mov_b32 v118, 0
    v_mov_b32 v119, 0
    v_mov_b32 v120, 0
    v_mov_b32 v121, 0
    v_mov_b32 v122, 0
    v_mov_b32 v123, 0
    v_mov_b32 v124, 0
    v_mov_b32 v125, 0
    v_mov_b32 v126, 0
    v_mov_b32 v127, 0
    s_mov_b32 s38, 0
    buffer_load_dwordx4 v[16:19], v2, s[24:27], s38 offen
    buffer_load_dwordx4 v[20:23], v3, s[24:27], s38 offen
    buffer_load_dwordx4 v[24:27], v4, s[24:27], s38 offen
    buffer_load_dwordx4 v[28:31], v5, s[24:27], s38 offen
    s_mov_b32 s38, 0
    buffer_load_dwordx2 v[32:33], v6, s[28:31], s38 offen
    buffer_load_dwordx2 v[34:35], v7, s[28:31], s38 offen
    buffer_load_dwordx2 v[36:37], v8, s[28:31], s38 offen
    buffer_load_dwordx2 v[38:39], v9, s[28:31], s38 offen
    buffer_load_dwordx2 v[56:57], v6, s[40:43], s38 offen
    buffer_load_dwordx2 v[58:59], v7, s[40:43], s38 offen
    buffer_load_dwordx2 v[60:61], v8, s[40:43], s38 offen
    buffer_load_dwordx2 v[62:63], v9, s[40:43], s38 offen
    s_waitcnt vmcnt(0)
    ds_write_b128 v10, v[16:19] offset:0
    ds_write_b128 v10, v[20:23] offset:4608
    ds_write_b128 v10, v[24:27] offset:9216
    ds_write_b128 v10, v[28:31] offset:13824
    v_cmp_ne_u32 vcc, 0, v48
    s_nop 1
    v_cndmask_b32 v32, v56, v32, vcc
    v_cndmask_b32 v33, v57, v33, vcc
    ds_write_b64 v44, v[32:33] offset:0
    v_cmp_ne_u32 vcc, 0, v49
    s_nop 1
    v_cndmask_b32 v34, v58, v34, vcc
    v_cndmask_b32 v35, v59, v35, vcc
    ds_write_b64 v45, v[34:35] offset:0
    v_cmp_ne_u32 vcc, 0, v50
    s_nop 1
    v_cndmask_b32 v36, v60, v36, vcc
    v_cndmask_b32 v37, v61, v37, vcc
    ds_write_b64 v46, v[36:37] offset:0
    v_cmp_ne_u32 vcc, 0, v51
    s_nop 1
    v_cndmask_b32 v38, v62, v38, vcc
    v_cndmask_b32 v39, v63, v39, vcc
    ds_write_b64 v47, v[38:39] offset:0
    s_waitcnt lgkmcnt(0)
    s_barrier
    s_mov_b32 s38, 128
    buffer_load_dwordx4 v[16:19], v2, s[24:27], s38 offen
    buffer_load_dwordx4 v[20:23], v3, s[24:27], s38 offen
    buffer_load_dwordx4 v[24:27], v4, s[24:27], s38 offen
    buffer_load_dwordx4 v[28:31], v5, s[24:27], s38 offen
    s_mov_b32 s38, 3584
    buffer_load_dwordx2 v[32:33], v6, s[28:31], s38 offen
    buffer_load_dwordx2 v[34:35], v7, s[28:31], s38 offen
    buffer_load_dwordx2 v[36:37], v8, s[28:31], s38 offen
    buffer_load_dwordx2 v[38:39], v9, s[28:31], s38 offen
    buffer_load_dwordx2 v[56:57], v6, s[40:43], s38 offen
    buffer_load_dwordx2 v[58:59], v7, s[40:43], s38 offen
    buffer_load_dwordx2 v[60:61], v8, s[40:43], s38 offen
    buffer_load_dwordx2 v[62:63], v9, s[40:43], s38 offen
    ds_read_b128 v[128:131], v52 offset:0
    ds_read_b128 v[132:135], v52 offset:4608
    ds_read_b64_tr_b16 v[136:137], v53 offset:0
    ds_read_b64_tr_b16 v[138:139], v53 offset:1280
    ds_read_b64_tr_b16 v[140:141], v53 offset:64
    ds_read_b64_tr_b16 v[142:143], v53 offset:1344
    s_waitcnt lgkmcnt(0)
    v_mfma_f32_32x32x16_bf16 v[64:79], v[136:139], v[128:131], v[64:79]
    v_mfma_f32_32x32x16_bf16 v[80:95], v[136:139], v[132:135], v[80:95]
    v_mfma_f32_32x32x16_bf16 v[96:111], v[140:143], v[128:131], v[96:111]
    v_mfma_f32_32x32x16_bf16 v[112:127], v[140:143], v[132:135], v[112:127]
    ds_read_b128 v[128:131], v52 offset:32
    ds_read_b128 v[132:135], v52 offset:4640
    ds_read_b64_tr_b16 v[136:137], v53 offset:5120
    ds_read_b64_tr_b16 v[138:139], v53 offset:6400
    ds_read_b64_tr_b16 v[140:141], v53 offset:5184
    ds_read_b64_tr_b16 v[142:143], v53 offset:6464
    s_waitcnt lgkmcnt(0)
    v_mfma_f32_32x32x16_bf16 v[64:79], v[136:139], v[128:131], v[64:79]
    v_mfma_f32_32x32x16_bf16 v[80:95], v[136:139], v[132:135], v[80:95]
    v_mfma_f32_32x32x16_bf16 v[96:111], v[140:143], v[128:131], v[96:111]
    v_mfma_f32_32x32x16_bf16 v[112:127], v[140:143], v[132:135], v[112:127]
    ds_read_b128 v[128:131], v52 offset:64
    ds_read_b128 v[132:135], v52 offset:4672
    ds_read_b64_tr_b16 v[136:137], v53 offset:10240
    ds_read_b64_tr_b16 v[138:139], v53 offset:11520
    ds_read_b64_tr_b16 v[140:141], v53 offset:10304
    ds_read_b64_tr_b16 v[142:143], v53 offset:11584
    s_waitcnt lgkmcnt(0)
    v_mfma_f32_32x32x16_bf16 v[64:79], v[136:139], v[128:131], v[64:79]
    v_mfma_f32_32x32x16_bf16 v[80:95], v[136:139], v[132:135], v[80:95]
    v_mfma_f32_32x32x16_bf16 v[96:111], v[140:143], v[128:131], v[96:111]
    v_mfma_f32_32x32x16_bf16 v[112:127], v[140:143], v[132:135], v[112:127]
    ds_read_b128 v[128:131], v52 offset:96
    ds_read_b128 v[132:135], v52 offset:4704
    ds_read_b64_tr_b16 v[136:137], v53 offset:15360
    ds_read_b64_tr_b16 v[138:139], v53 offset:16640
    ds_read_b64_tr_b16 v[140:141], v53 offset:15424
    ds_read_b64_tr_b16 v[142:143], v53 offset:16704
    s_waitcnt lgkmcnt(0)
    v_mfma_f32_32x32x16_bf16 v[64:79], v[136:139], v[128:131], v[64:79]
    v_mfma_f32_32x32x16_bf16 v[80:95], v[136:139], v[132:135], v[80:95]
    v_mfma_f32_32x32x16_bf16 v[96:111], v[140:143], v[128:131], v[96:111]
    v_mfma_f32_32x32x16_bf16 v[112:127], v[140:143], v[132:135], v[112:127]
    s_waitcnt vmcnt(0)
    ds_write_b128 v10, v[16:19] offset:38912
    ds_write_b128 v10, v[20:23] offset:43520
    ds_write_b128 v10, v[24:27] offset:48128
    ds_write_b128 v10, v[28:31] offset:52736
    v_cmp_ne_u32 vcc, 0, v48
    s_nop 1
    v_cndmask_b32 v32, v56, v32, vcc
    v_cndmask_b32 v33, v57, v33, vcc
    ds_write_b64 v44, v[32:33] offset:38912
    v_cmp_ne_u32 vcc, 0, v49
    s_nop 1
    v_cndmask_b32 v34, v58, v34, vcc
    v_cndmask_b32 v35, v59, v35, vcc
    ds_write_b64 v45, v[34:35] offset:38912
    v_cmp_ne_u32 vcc, 0, v50
    s_nop 1
    v_cndmask_b32 v36, v60, v36, vcc
    v_cndmask_b32 v37, v61, v37, vcc
    ds_write_b64 v46, v[36:37] offset:38912
    v_cmp_ne_u32 vcc, 0, v51
    s_nop 1
    v_cndmask_b32 v38, v62, v38, vcc
    v_cndmask_b32 v39, v63, v39, vcc
    ds_write_b64 v47, v[38:39] offset:38912
    s_waitcnt lgkmcnt(0)
    s_barrier
    s_mov_b32 s38, 256
    buffer_load_dwordx4 v[16:19], v2, s[24:27], s38 offen
    buffer_load_dwordx4 v[20:23], v3, s[24:27], s38 offen
    buffer_load_dwordx4 v[24:27], v4, s[24:27], s38 offen
    buffer_load_dwordx4 v[28:31], v5, s[24:27], s38 offen
    s_mov_b32 s38, 7168
    buffer_load_dwordx2 v[32:33], v6, s[28:31], s38 offen
    buffer_load_dwordx2 v[34:35], v7, s[28:31], s38 offen
    buffer_load_dwordx2 v[36:37], v8, s[28:31], s38 offen
    buffer_load_dwordx2 v[38:39], v9, s[28:31], s38 offen
    buffer_load_dwordx2 v[56:57], v6, s[40:43], s38 offen
    buffer_load_dwordx2 v[58:59], v7, s[40:43], s38 offen
    buffer_load_dwordx2 v[60:61], v8, s[40:43], s38 offen
    buffer_load_dwordx2 v[62:63], v9, s[40:43], s38 offen
    ds_read_b128 v[128:131], v52 offset:38912
    ds_read_b128 v[132:135], v52 offset:43520
    ds_read_b64_tr_b16 v[136:137], v53 offset:38912
    ds_read_b64_tr_b16 v[138:139], v53 offset:40192
    ds_read_b64_tr_b16 v[140:141], v53 offset:38976
    ds_read_b64_tr_b16 v[142:143], v53 offset:40256
    s_waitcnt lgkmcnt(0)
    v_mfma_f32_32x32x16_bf16 v[64:79], v[136:139], v[128:131], v[64:79]
    v_mfma_f32_32x32x16_bf16 v[80:95], v[136:139], v[132:135], v[80:95]
    v_mfma_f32_32x32x16_bf16 v[96:111], v[140:143], v[128:131], v[96:111]
    v_mfma_f32_32x32x16_bf16 v[112:127], v[140:143], v[132:135], v[112:127]
    ds_read_b128 v[128:131], v52 offset:38944
    ds_read_b128 v[132:135], v52 offset:43552
    ds_read_b64_tr_b16 v[136:137], v53 offset:44032
    ds_read_b64_tr_b16 v[138:139], v53 offset:45312
    ds_read_b64_tr_b16 v[140:141], v53 offset:44096
    ds_read_b64_tr_b16 v[142:143], v53 offset:45376
    s_waitcnt lgkmcnt(0)
    v_mfma_f32_32x32x16_bf16 v[64:79], v[136:139], v[128:131], v[64:79]
    v_mfma_f32_32x32x16_bf16 v[80:95], v[136:139], v[132:135], v[80:95]
    v_mfma_f32_32x32x16_bf16 v[96:111], v[140:143], v[128:131], v[96:111]
    v_mfma_f32_32x32x16_bf16 v[112:127], v[140:143], v[132:135], v[112:127]
    ds_read_b128 v[128:131], v52 offset:38976
    ds_read_b128 v[132:135], v52 offset:43584
    ds_read_b64_tr_b16 v[136:137], v53 offset:49152
    ds_read_b64_tr_b16 v[138:139], v53 offset:50432
    ds_read_b64_tr_b16 v[140:141], v53 offset:49216
    ds_read_b64_tr_b16 v[142:143], v53 offset:50496
    s_waitcnt lgkmcnt(0)
    v_mfma_f32_32x32x16_bf16 v[64:79], v[136:139], v[128:131], v[64:79]
    v_mfma_f32_32x32x16_bf16 v[80:95], v[136:139], v[132:135], v[80:95]
    v_mfma_f32_32x32x16_bf16 v[96:111], v[140:143], v[128:131], v[96:111]
    v_mfma_f32_32x32x16_bf16 v[112:127], v[140:143], v[132:135], v[112:127]
    ds_read_b128 v[128:131], v52 offset:39008
    ds_read_b128 v[132:135], v52 offset:43616
    ds_read_b64_tr_b16 v[136:137], v53 offset:54272
    ds_read_b64_tr_b16 v[138:139], v53 offset:55552
    ds_read_b64_tr_b16 v[140:141], v53 offset:54336
    ds_read_b64_tr_b16 v[142:143], v53 offset:55616
    s_waitcnt lgkmcnt(0)
    v_mfma_f32_32x32x16_bf16 v[64:79], v[136:139], v[128:131], v[64:79]
    v_mfma_f32_32x32x16_bf16 v[80:95], v[136:139], v[132:135], v[80:95]
    v_mfma_f32_32x32x16_bf16 v[96:111], v[140:143], v[128:131], v[96:111]
    v_mfma_f32_32x32x16_bf16 v[112:127], v[140:143], v[132:135], v[112:127]
    s_waitcnt vmcnt(0)
    ds_write_b128 v10, v[16:19] offset:0
    ds_write_b128 v10, v[20:23] offset:4608
    ds_write_b128 v10, v[24:27] offset:9216
    ds_write_b128 v10, v[28:31] offset:13824
    v_cmp_ne_u32 vcc, 0, v48
    s_nop 1
    v_cndmask_b32 v32, v56, v32, vcc
    v_cndmask_b32 v33, v57, v33, vcc
    ds_write_b64 v44, v[32:33] offset:0
    v_cmp_ne_u32 vcc, 0, v49
    s_nop 1
    v_cndmask_b32 v34, v58, v34, vcc
    v_cndmask_b32 v35, v59, v35, vcc
    ds_write_b64 v45, v[34:35] offset:0
    v_cmp_ne_u32 vcc, 0, v50
    s_nop 1
    v_cndmask_b32 v36, v60, v36, vcc
    v_cndmask_b32 v37, v61, v37, vcc
    ds_write_b64 v46, v[36:37] offset:0
    v_cmp_ne_u32 vcc, 0, v51
    s_nop 1
    v_cndmask_b32 v38, v62, v38, vcc
    v_cndmask_b32 v39, v63, v39, vcc
    ds_write_b64 v47, v[38:39] offset:0
    s_waitcnt lgkmcnt(0)
    s_barrier
    s_mov_b32 s38, 384
    buffer_load_dwordx4 v[16:19], v2, s[24:27], s38 offen
    buffer_load_dwordx4 v[20:23], v3, s[24:27], s38 offen
    buffer_load_dwordx4 v[24:27], v4, s[24:27], s38 offen
    buffer_load_dwordx4 v[28:31], v5, s[24:27], s38 offen
    s_mov_b32 s38, 10752
    buffer_load_dwordx2 v[32:33], v6, s[28:31], s38 offen
    buffer_load_dwordx2 v[34:35], v7, s[28:31], s38 offen
    buffer_load_dwordx2 v[36:37], v8, s[28:31], s38 offen
    buffer_load_dwordx2 v[38:39], v9, s[28:31], s38 offen
    buffer_load_dwordx2 v[56:57], v6, s[40:43], s38 offen
    buffer_load_dwordx2 v[58:59], v7, s[40:43], s38 offen
    buffer_load_dwordx2 v[60:61], v8, s[40:43], s38 offen
    buffer_load_dwordx2 v[62:63], v9, s[40:43], s38 offen
    ds_read_b128 v[128:131], v52 offset:0
    ds_read_b128 v[132:135], v52 offset:4608
    ds_read_b64_tr_b16 v[136:137], v53 offset:0
    ds_read_b64_tr_b16 v[138:139], v53 offset:1280
    ds_read_b64_tr_b16 v[140:141], v53 offset:64
    ds_read_b64_tr_b16 v[142:143], v53 offset:1344
    s_waitcnt lgkmcnt(0)
    v_mfma_f32_32x32x16_bf16 v[64:79], v[136:139], v[128:131], v[64:79]
    v_mfma_f32_32x32x16_bf16 v[80:95], v[136:139], v[132:135], v[80:95]
    v_mfma_f32_32x32x16_bf16 v[96:111], v[140:143], v[128:131], v[96:111]
    v_mfma_f32_32x32x16_bf16 v[112:127], v[140:143], v[132:135], v[112:127]
    ds_read_b128 v[128:131], v52 offset:32
    ds_read_b128 v[132:135], v52 offset:4640
    ds_read_b64_tr_b16 v[136:137], v53 offset:5120
    ds_read_b64_tr_b16 v[138:139], v53 offset:6400
    ds_read_b64_tr_b16 v[140:141], v53 offset:5184
    ds_read_b64_tr_b16 v[142:143], v53 offset:6464
    s_waitcnt lgkmcnt(0)
    v_mfma_f32_32x32x16_bf16 v[64:79], v[136:139], v[128:131], v[64:79]
    v_mfma_f32_32x32x16_bf16 v[80:95], v[136:139], v[132:135], v[80:95]
    v_mfma_f32_32x32x16_bf16 v[96:111], v[140:143], v[128:131], v[96:111]
    v_mfma_f32_32x32x16_bf16 v[112:127], v[140:143], v[132:135], v[112:127]
    ds_read_b128 v[128:131], v52 offset:64
    ds_read_b128 v[132:135], v52 offset:4672
    ds_read_b64_tr_b16 v[136:137], v53 offset:10240
    ds_read_b64_tr_b16 v[138:139], v53 offset:11520
    ds_read_b64_tr_b16 v[140:141], v53 offset:10304
    ds_read_b64_tr_b16 v[142:143], v53 offset:11584
    s_waitcnt lgkmcnt(0)
    v_mfma_f32_32x32x16_bf16 v[64:79], v[136:139], v[128:131], v[64:79]
    v_mfma_f32_32x32x16_bf16 v[80:95], v[136:139], v[132:135], v[80:95]
    v_mfma_f32_32x32x16_bf16 v[96:111], v[140:143], v[128:131], v[96:111]
    v_mfma_f32_32x32x16_bf16 v[112:127], v[140:143], v[132:135], v[112:127]
    ds_read_b128 v[128:131], v52 offset:96
    ds_read_b128 v[132:135], v52 offset:4704
    ds_read_b64_tr_b16 v[136:137], v53 offset:15360
    ds_read_b64_tr_b16 v[138:139], v53 offset:16640
    ds_read_b64_tr_b16 v[140:141], v53 offset:15424
    ds_read_b64_tr_b16 v[142:143], v53 offset:16704
    s_waitcnt lgkmcnt(0)
    v_mfma_f32_32x32x16_bf16 v[64:79], v[136:139], v[128:131], v[64:79]
    v_mfma_f32_32x32x16_bf16 v[80:95], v[136:139], v[132:135], v[80:95]
    v_mfma_f32_32x32x16_bf16 v[96:111], v[140:143], v[128:131], v[96:111]
    v_mfma_f32_32x32x16_bf16 v[112:127], v[140:143], v[132:135], v[112:127]
    s_waitcnt vmcnt(0)
    ds_write_b128 v10, v[16:19] offset:38912
    ds_write_b128 v10, v[20:23] offset:43520
    ds_write_b128 v10, v[24:27] offset:48128
    ds_write_b128 v10, v[28:31] offset:52736
    v_cmp_ne_u32 vcc, 0, v48
    s_nop 1
    v_cndmask_b32 v32, v56, v32, vcc
    v_cndmask_b32 v33, v57, v33, vcc
    ds_write_b64 v44, v[32:33] offset:38912
    v_cmp_ne_u32 vcc, 0, v49
    s_nop 1
    v_cndmask_b32 v34, v58, v34, vcc
    v_cndmask_b32 v35, v59, v35, vcc
    ds_write_b64 v45, v[34:35] offset:38912
    v_cmp_ne_u32 vcc, 0, v50
    s_nop 1
    v_cndmask_b32 v36, v60, v36, vcc
    v_cndmask_b32 v37, v61, v37, vcc
    ds_write_b64 v46, v[36:37] offset:38912
    v_cmp_ne_u32 vcc, 0, v51
    s_nop 1
    v_cndmask_b32 v38, v62, v38, vcc
    v_cndmask_b32 v39, v63, v39, vcc
    ds_write_b64 v47, v[38:39] offset:38912
    s_waitcnt lgkmcnt(0)
    s_barrier
    s_mov_b32 s38, 512
    buffer_load_dwordx4 v[16:19], v2, s[24:27], s38 offen
    buffer_load_dwordx4 v[20:23], v3, s[24:27], s38 offen
    buffer_load_dwordx4 v[24:27], v4, s[24:27], s38 offen
    buffer_load_dwordx4 v[28:31], v5, s[24:27], s38 offen
    s_mov_b32 s38, 14336
    buffer_load_dwordx2 v[32:33], v6, s[28:31], s38 offen
    buffer_load_dwordx2 v[34:35], v7, s[28:31], s38 offen
    buffer_load_dwordx2 v[36:37], v8, s[28:31], s38 offen
    buffer_load_dwordx2 v[38:39], v9, s[28:31], s38 offen
    buffer_load_dwordx2 v[56:57], v6, s[40:43], s38 offen
    buffer_load_dwordx2 v[58:59], v7, s[40:43], s38 offen
    buffer_load_dwordx2 v[60:61], v8, s[40:43], s38 offen
    buffer_load_dwordx2 v[62:63], v9, s[40:43], s38 offen
    ds_read_b128 v[128:131], v52 offset:38912
    ds_read_b128 v[132:135], v52 offset:43520
    ds_read_b64_tr_b16 v[136:137], v53 offset:38912
    ds_read_b64_tr_b16 v[138:139], v53 offset:40192
    ds_read_b64_tr_b16 v[140:141], v53 offset:38976
    ds_read_b64_tr_b16 v[142:143], v53 offset:40256
    s_waitcnt lgkmcnt(0)
    v_mfma_f32_32x32x16_bf16 v[64:79], v[136:139], v[128:131], v[64:79]
    v_mfma_f32_32x32x16_bf16 v[80:95], v[136:139], v[132:135], v[80:95]
    v_mfma_f32_32x32x16_bf16 v[96:111], v[140:143], v[128:131], v[96:111]
    v_mfma_f32_32x32x16_bf16 v[112:127], v[140:143], v[132:135], v[112:127]
    ds_read_b128 v[128:131], v52 offset:38944
    ds_read_b128 v[132:135], v52 offset:43552
    ds_read_b64_tr_b16 v[136:137], v53 offset:44032
    ds_read_b64_tr_b16 v[138:139], v53 offset:45312
    ds_read_b64_tr_b16 v[140:141], v53 offset:44096
    ds_read_b64_tr_b16 v[142:143], v53 offset:45376
    s_waitcnt lgkmcnt(0)
    v_mfma_f32_32x32x16_bf16 v[64:79], v[136:139], v[128:131], v[64:79]
    v_mfma_f32_32x32x16_bf16 v[80:95], v[136:139], v[132:135], v[80:95]
    v_mfma_f32_32x32x16_bf16 v[96:111], v[140:143], v[128:131], v[96:111]
    v_mfma_f32_32x32x16_bf16 v[112:127], v[140:143], v[132:135], v[112:127]
    ds_read_b128 v[128:131], v52 offset:38976
    ds_read_b128 v[132:135], v52 offset:43584
    ds_read_b64_tr_b16 v[136:137], v53 offset:49152
    ds_read_b64_tr_b16 v[138:139], v53 offset:50432
    ds_read_b64_tr_b16 v[140:141], v53 offset:49216
    ds_read_b64_tr_b16 v[142:143], v53 offset:50496
    s_waitcnt lgkmcnt(0)
    v_mfma_f32_32x32x16_bf16 v[64:79], v[136:139], v[128:131], v[64:79]
    v_mfma_f32_32x32x16_bf16 v[80:95], v[136:139], v[132:135], v[80:95]
    v_mfma_f32_32x32x16_bf16 v[96:111], v[140:143], v[128:131], v[96:111]
    v_mfma_f32_32x32x16_bf16 v[112:127], v[140:143], v[132:135], v[112:127]
    ds_read_b128 v[128:131], v52 offset:39008
    ds_read_b128 v[132:135], v52 offset:43616
    ds_read_b64_tr_b16 v[136:137], v53 offset:54272
    ds_read_b64_tr_b16 v[138:139], v53 offset:55552
    ds_read_b64_tr_b16 v[140:141], v53 offset:54336
    ds_read_b64_tr_b16 v[142:143], v53 offset:55616
    s_waitcnt lgkmcnt(0)
    v_mfma_f32_32x32x16_bf16 v[64:79], v[136:139], v[128:131], v[64:79]
    v_mfma_f32_32x32x16_bf16 v[80:95], v[136:139], v[132:135], v[80:95]
    v_mfma_f32_32x32x16_bf16 v[96:111], v[140:143], v[128:131], v[96:111]
    v_mfma_f32_32x32x16_bf16 v[112:127], v[140:143], v[132:135], v[112:127]
    s_waitcnt vmcnt(0)
    ds_write_b128 v10, v[16:19] offset:0
    ds_write_b128 v10, v[20:23] offset:4608
    ds_write_b128 v10, v[24:27] offset:9216
    ds_write_b128 v10, v[28:31] offset:13824
    v_cmp_ne_u32 vcc, 0, v48
    s_nop 1
    v_cndmask_b32 v32, v56, v32, vcc
    v_cndmask_b32 v33, v57, v33, vcc
    ds_write_b64 v44, v[32:33] offset:0
    v_cmp_ne_u32 vcc, 0, v49
    s_nop 1
    v_cndmask_b32 v34, v58, v34, vcc
    v_cndmask_b32 v35, v59, v35, vcc
    ds_write_b64 v45, v[34:35] offset:0
    v_cmp_ne_u32 vcc, 0, v50
    s_nop 1
    v_cndmask_b32 v36, v60, v36, vcc
    v_cndmask_b32 v37, v61, v37, vcc
    ds_write_b64 v46, v[36:37] offset:0
    v_cmp_ne_u32 vcc, 0, v51
    s_nop 1
    v_cndmask_b32 v38, v62, v38, vcc
    v_cndmask_b32 v39, v63, v39, vcc
    ds_write_b64 v47, v[38:39] offset:0
    s_waitcnt lgkmcnt(0)
    s_barrier
    s_mov_b32 s38, 640
    buffer_load_dwordx4 v[16:19], v2, s[24:27], s38 offen
    buffer_load_dwordx4 v[20:23], v3, s[24:27], s38 offen
    buffer_load_dwordx4 v[24:27], v4, s[24:27], s38 offen
    buffer_load_dwordx4 v[28:31], v5, s[24:27], s38 offen
    s_mov_b32 s38, 17920
    buffer_load_dwordx2 v[32:33], v6, s[28:31], s38 offen
    buffer_load_dwordx2 v[34:35], v7, s[28:31], s38 offen
    buffer_load_dwordx2 v[36:37], v8, s[28:31], s38 offen
    buffer_load_dwordx2 v[38:39], v9, s[28:31], s38 offen
    buffer_load_dwordx2 v[56:57], v6, s[40:43], s38 offen
    buffer_load_dwordx2 v[58:59], v7, s[40:43], s38 offen
    buffer_load_dwordx2 v[60:61], v8, s[40:43], s38 offen
    buffer_load_dwordx2 v[62:63], v9, s[40:43], s38 offen
    ds_read_b128 v[128:131], v52 offset:0
    ds_read_b128 v[132:135], v52 offset:4608
    ds_read_b64_tr_b16 v[136:137], v53 offset:0
    ds_read_b64_tr_b16 v[138:139], v53 offset:1280
    ds_read_b64_tr_b16 v[140:141], v53 offset:64
    ds_read_b64_tr_b16 v[142:143], v53 offset:1344
    s_waitcnt lgkmcnt(0)
    v_mfma_f32_32x32x16_bf16 v[64:79], v[136:139], v[128:131], v[64:79]
    v_mfma_f32_32x32x16_bf16 v[80:95], v[136:139], v[132:135], v[80:95]
    v_mfma_f32_32x32x16_bf16 v[96:111], v[140:143], v[128:131], v[96:111]
    v_mfma_f32_32x32x16_bf16 v[112:127], v[140:143], v[132:135], v[112:127]
    ds_read_b128 v[128:131], v52 offset:32
    ds_read_b128 v[132:135], v52 offset:4640
    ds_read_b64_tr_b16 v[136:137], v53 offset:5120
    ds_read_b64_tr_b16 v[138:139], v53 offset:6400
    ds_read_b64_tr_b16 v[140:141], v53 offset:5184
    ds_read_b64_tr_b16 v[142:143], v53 offset:6464
    s_waitcnt lgkmcnt(0)
    v_mfma_f32_32x32x16_bf16 v[64:79], v[136:139], v[128:131], v[64:79]
    v_mfma_f32_32x32x16_bf16 v[80:95], v[136:139], v[132:135], v[80:95]
    v_mfma_f32_32x32x16_bf16 v[96:111], v[140:143], v[128:131], v[96:111]
    v_mfma_f32_32x32x16_bf16 v[112:127], v[140:143], v[132:135], v[112:127]
    ds_read_b128 v[128:131], v52 offset:64
    ds_read_b128 v[132:135], v52 offset:4672
    ds_read_b64_tr_b16 v[136:137], v53 offset:10240
    ds_read_b64_tr_b16 v[138:139], v53 offset:11520
    ds_read_b64_tr_b16 v[140:141], v53 offset:10304
    ds_read_b64_tr_b16 v[142:143], v53 offset:11584
    s_waitcnt lgkmcnt(0)
    v_mfma_f32_32x32x16_bf16 v[64:79], v[136:139], v[128:131], v[64:79]
    v_mfma_f32_32x32x16_bf16 v[80:95], v[136:139], v[132:135], v[80:95]
    v_mfma_f32_32x32x16_bf16 v[96:111], v[140:143], v[128:131], v[96:111]
    v_mfma_f32_32x32x16_bf16 v[112:127], v[140:143], v[132:135], v[112:127]
    ds_read_b128 v[128:131], v52 offset:96
    ds_read_b128 v[132:135], v52 offset:4704
    ds_read_b64_tr_b16 v[136:137], v53 offset:15360
    ds_read_b64_tr_b16 v[138:139], v53 offset:16640
    ds_read_b64_tr_b16 v[140:141], v53 offset:15424
    ds_read_b64_tr_b16 v[142:143], v53 offset:16704
    s_waitcnt lgkmcnt(0)
    v_mfma_f32_32x32x16_bf16 v[64:79], v[136:139], v[128:131], v[64:79]
    v_mfma_f32_32x32x16_bf16 v[80:95], v[136:139], v[132:135], v[80:95]
    v_mfma_f32_32x32x16_bf16 v[96:111], v[140:143], v[128:131], v[96:111]
    v_mfma_f32_32x32x16_bf16 v[112:127], v[140:143], v[132:135], v[112:127]
    s_waitcnt vmcnt(0)
    ds_write_b128 v10, v[16:19] offset:38912
    ds_write_b128 v10, v[20:23] offset:43520
    ds_write_b128 v10, v[24:27] offset:48128
    ds_write_b128 v10, v[28:31] offset:52736
    v_cmp_ne_u32 vcc, 0, v48
    s_nop 1
    v_cndmask_b32 v32, v56, v32, vcc
    v_cndmask_b32 v33, v57, v33, vcc
    ds_write_b64 v44, v[32:33] offset:38912
    v_cmp_ne_u32 vcc, 0, v49
    s_nop 1
    v_cndmask_b32 v34, v58, v34, vcc
    v_cndmask_b32 v35, v59, v35, vcc
    ds_write_b64 v45, v[34:35] offset:38912
    v_cmp_ne_u32 vcc, 0, v50
    s_nop 1
    v_cndmask_b32 v36, v60, v36, vcc
    v_cndmask_b32 v37, v61, v37, vcc
    ds_write_b64 v46, v[36:37] offset:38912
    v_cmp_ne_u32 vcc, 0, v51
    s_nop 1
    v_cndmask_b32 v38, v62, v38, vcc
    v_cndmask_b32 v39, v63, v39, vcc
    ds_write_b64 v47, v[38:39] offset:38912
    s_waitcnt lgkmcnt(0)
    s_barrier
    s_mov_b32 s38, 768
    buffer_load_dwordx4 v[16:19], v2, s[24:27], s38 offen
    buffer_load_dwordx4 v[20:23], v3, s[24:27], s38 offen
    buffer_load_dwordx4 v[24:27], v4, s[24:27], s38 offen
    buffer_load_dwordx4 v[28:31], v5, s[24:27], s38 offen
    s_mov_b32 s38, 21504
    buffer_load_dwordx2 v[32:33], v6, s[28:31], s38 offen
    buffer_load_dwordx2 v[34:35], v7, s[28:31], s38 offen
    buffer_load_dwordx2 v[36:37], v8, s[28:31], s38 offen
    buffer_load_dwordx2 v[38:39], v9, s[28:31], s38 offen
    buffer_load_dwordx2 v[56:57], v6, s[40:43], s38 offen
    buffer_load_dwordx2 v[58:59], v7, s[40:43], s38 offen
    buffer_load_dwordx2 v[60:61], v8, s[40:43], s38 offen
    buffer_load_dwordx2 v[62:63], v9, s[40:43], s38 offen
    ds_read_b128 v[128:131], v52 offset:38912
    ds_read_b128 v[132:135], v52 offset:43520
    ds_read_b64_tr_b16 v[136:137], v53 offset:38912
    ds_read_b64_tr_b16 v[138:139], v53 offset:40192
    ds_read_b64_tr_b16 v[140:141], v53 offset:38976
    ds_read_b64_tr_b16 v[142:143], v53 offset:40256
    s_waitcnt lgkmcnt(0)
    v_mfma_f32_32x32x16_bf16 v[64:79], v[136:139], v[128:131], v[64:79]
    v_mfma_f32_32x32x16_bf16 v[80:95], v[136:139], v[132:135], v[80:95]
    v_mfma_f32_32x32x16_bf16 v[96:111], v[140:143], v[128:131], v[96:111]
    v_mfma_f32_32x32x16_bf16 v[112:127], v[140:143], v[132:135], v[112:127]
    ds_read_b128 v[128:131], v52 offset:38944
    ds_read_b128 v[132:135], v52 offset:43552
    ds_read_b64_tr_b16 v[136:137], v53 offset:44032
    ds_read_b64_tr_b16 v[138:139], v53 offset:45312
    ds_read_b64_tr_b16 v[140:141], v53 offset:44096
    ds_read_b64_tr_b16 v[142:143], v53 offset:45376
    s_waitcnt lgkmcnt(0)
    v_mfma_f32_32x32x16_bf16 v[64:79], v[136:139], v[128:131], v[64:79]
    v_mfma_f32_32x32x16_bf16 v[80:95], v[136:139], v[132:135], v[80:95]
    v_mfma_f32_32x32x16_bf16 v[96:111], v[140:143], v[128:131], v[96:111]
    v_mfma_f32_32x32x16_bf16 v[112:127], v[140:143], v[132:135], v[112:127]
    ds_read_b128 v[128:131], v52 offset:38976
    ds_read_b128 v[132:135], v52 offset:43584
    ds_read_b64_tr_b16 v[136:137], v53 offset:49152
    ds_read_b64_tr_b16 v[138:139], v53 offset:50432
    ds_read_b64_tr_b16 v[140:141], v53 offset:49216
    ds_read_b64_tr_b16 v[142:143], v53 offset:50496
    s_waitcnt lgkmcnt(0)
    v_mfma_f32_32x32x16_bf16 v[64:79], v[136:139], v[128:131], v[64:79]
    v_mfma_f32_32x32x16_bf16 v[80:95], v[136:139], v[132:135], v[80:95]
    v_mfma_f32_32x32x16_bf16 v[96:111], v[140:143], v[128:131], v[96:111]
    v_mfma_f32_32x32x16_bf16 v[112:127], v[140:143], v[132:135], v[112:127]
    ds_read_b128 v[128:131], v52 offset:39008
    ds_read_b128 v[132:135], v52 offset:43616
    ds_read_b64_tr_b16 v[136:137], v53 offset:54272
    ds_read_b64_tr_b16 v[138:139], v53 offset:55552
    ds_read_b64_tr_b16 v[140:141], v53 offset:54336
    ds_read_b64_tr_b16 v[142:143], v53 offset:55616
    s_waitcnt lgkmcnt(0)
    v_mfma_f32_32x32x16_bf16 v[64:79], v[136:139], v[128:131], v[64:79]
    v_mfma_f32_32x32x16_bf16 v[80:95], v[136:139], v[132:135], v[80:95]
    v_mfma_f32_32x32x16_bf16 v[96:111], v[140:143], v[128:131], v[96:111]
    v_mfma_f32_32x32x16_bf16 v[112:127], v[140:143], v[132:135], v[112:127]
    s_waitcnt vmcnt(0)
    ds_write_b128 v10, v[16:19] offset:0
    ds_write_b128 v10, v[20:23] offset:4608
    ds_write_b128 v10, v[24:27] offset:9216
    ds_write_b128 v10, v[28:31] offset:13824
    v_cmp_ne_u32 vcc, 0, v48
    s_nop 1
    v_cndmask_b32 v32, v56, v32, vcc
    v_cndmask_b32 v33, v57, v33, vcc
    ds_write_b64 v44, v[32:33] offset:0
    v_cmp_ne_u32 vcc, 0, v49
    s_nop 1
    v_cndmask_b32 v34, v58, v34, vcc
    v_cndmask_b32 v35, v59, v35, vcc
    ds_write_b64 v45, v[34:35] offset:0
    v_cmp_ne_u32 vcc, 0, v50
    s_nop 1
    v_cndmask_b32 v36, v60, v36, vcc
    v_cndmask_b32 v37, v61, v37, vcc
    ds_write_b64 v46, v[36:37] offset:0
    v_cmp_ne_u32 vcc, 0, v51
    s_nop 1
    v_cndmask_b32 v38, v62, v38, vcc
    v_cndmask_b32 v39, v63, v39, vcc
    ds_write_b64 v47, v[38:39] offset:0
    s_waitcnt lgkmcnt(0)
    s_barrier
    ds_read_b128 v[128:131], v52 offset:0
    ds_read_b128 v[132:135], v52 offset:4608
    ds_read_b64_tr_b16 v[136:137], v53 offset:0
    ds_read_b64_tr_b16 v[138:139], v53 offset:1280
    ds_read_b64_tr_b16 v[140:141], v53 offset:64
    ds_read_b64_tr_b16 v[142:143], v53 offset:1344
    s_waitcnt lgkmcnt(0)
    v_mfma_f32_32x32x16_bf16 v[64:79], v[136:139], v[128:131], v[64:79]
    v_mfma_f32_32x32x16_bf16 v[80:95], v[136:139], v[132:135], v[80:95]
    v_mfma_f32_32x32x16_bf16 v[96:111], v[140:143], v[128:131], v[96:111]
    v_mfma_f32_32x32x16_bf16 v[112:127], v[140:143], v[132:135], v[112:127]
    ds_read_b128 v[128:131], v52 offset:32
    ds_read_b128 v[132:135], v52 offset:4640
    ds_read_b64_tr_b16 v[136:137], v53 offset:5120
    ds_read_b64_tr_b16 v[138:139], v53 offset:6400
    ds_read_b64_tr_b16 v[140:141], v53 offset:5184
    ds_read_b64_tr_b16 v[142:143], v53 offset:6464
    s_waitcnt lgkmcnt(0)
    v_mfma_f32_32x32x16_bf16 v[64:79], v[136:139], v[128:131], v[64:79]
    v_mfma_f32_32x32x16_bf16 v[80:95], v[136:139], v[132:135], v[80:95]
    v_mfma_f32_32x32x16_bf16 v[96:111], v[140:143], v[128:131], v[96:111]
    v_mfma_f32_32x32x16_bf16 v[112:127], v[140:143], v[132:135], v[112:127]
    ds_read_b128 v[128:131], v52 offset:64
    ds_read_b128 v[132:135], v52 offset:4672
    ds_read_b64_tr_b16 v[136:137], v53 offset:10240
    ds_read_b64_tr_b16 v[138:139], v53 offset:11520
    ds_read_b64_tr_b16 v[140:141], v53 offset:10304
    ds_read_b64_tr_b16 v[142:143], v53 offset:11584
    s_waitcnt lgkmcnt(0)
    v_mfma_f32_32x32x16_bf16 v[64:79], v[136:139], v[128:131], v[64:79]
    v_mfma_f32_32x32x16_bf16 v[80:95], v[136:139], v[132:135], v[80:95]
    v_mfma_f32_32x32x16_bf16 v[96:111], v[140:143], v[128:131], v[96:111]
    v_mfma_f32_32x32x16_bf16 v[112:127], v[140:143], v[132:135], v[112:127]
    ds_read_b128 v[128:131], v52 offset:96
    ds_read_b128 v[132:135], v52 offset:4704
    ds_read_b64_tr_b16 v[136:137], v53 offset:15360
    ds_read_b64_tr_b16 v[138:139], v53 offset:16640
    ds_read_b64_tr_b16 v[140:141], v53 offset:15424
    ds_read_b64_tr_b16 v[142:143], v53 offset:16704
    s_waitcnt lgkmcnt(0)
    v_mfma_f32_32x32x16_bf16 v[64:79], v[136:139], v[128:131], v[64:79]
    v_mfma_f32_32x32x16_bf16 v[80:95], v[136:139], v[132:135], v[80:95]
    v_mfma_f32_32x32x16_bf16 v[96:111], v[140:143], v[128:131], v[96:111]
    v_mfma_f32_32x32x16_bf16 v[112:127], v[140:143], v[132:135], v[112:127]
    s_nop 15
    v_and_b32 v2, 31, v1
    s_lshl_b32 s35, s36, 6
    s_add_u32 s35, s35, s39
    v_add_u32 v2, s35, v2
    v_lshrrev_b32 v3, 5, v1
    v_lshlrev_b32 v3, 2, v3
    s_mul_i32 s35, s37, 64
    v_add_u32 v3, s35, v3
    s_cmp_lg_u32 s37, 0
    s_cbranch_scc1 K1_END
    v_mov_b32 v10, 0
    v_mov_b32 v11, 0
    v_mov_b32 v15, 0x3f80
    v_mov_b32 v16, 0
    v_add_u32 v6, 0, v3
    v_add_u32 v13, 0, v2
    v_lshrrev_b32 v14, 5, v13
    v_lshlrev_b32 v14, 12, v14
    v_add_u32 v14, 2097152, v14
    v_and_b32 v13, 31, v13
    v_cmp_gt_u32 vcc, 28, v6
    s_and_saveexec_b64 s[48:49], vcc
    v_lshl_add_u32 v14, v13, 4, v14
    v_lshrrev_b32 v12, 3, v6
    v_lshl_add_u32 v14, v12, 9, v14
    v_and_b32 v12, 7, v6
    v_lshl_add_u32 v14, v12, 1, v14
    v_cvt_pk_bf16_f32 v8, v64, v65
    v_cvt_pk_bf16_f32 v9, v66, v67
    v_cmp_eq_u32 vcc, 24, v6
    s_and_saveexec_b64 s[50:51], vcc
    buffer_store_dwordx4 v[8:11], v14, s[44:47], 0 offen
    s_andn2_b64 exec, s[50:51], exec
    buffer_store_dwordx2 v[8:9], v14, s[44:47], 0 offen
    s_mov_b64 exec, s[48:49]
    s_nop 1
    v_add_u32 v13, 32, v2
    v_lshrrev_b32 v14, 5, v13
    v_lshlrev_b32 v14, 12, v14
    v_add_u32 v14, 2097152, v14
    v_and_b32 v13, 31, v13
    v_cmp_gt_u32 vcc, 28, v6
    s_and_saveexec_b64 s[48:49], vcc
    v_lshl_add_u32 v14, v13, 4, v14
    v_lshrrev_b32 v12, 3, v6
    v_lshl_add_u32 v14, v12, 9, v14
    v_and_b32 v12, 7, v6
    v_lshl_add_u32 v14, v12, 1, v14
    v_cvt_pk_bf16_f32 v8, v80, v81
    v_cvt_pk_bf16_f32 v9, v82, v83
    v_cmp_eq_u32 vcc, 24, v6
    s_and_saveexec_b64 s[50:51], vcc
    buffer_store_dwordx4 v[8:11], v14, s[44:47], 0 offen
    s_andn2_b64 exec, s[50:51], exec
    buffer_store_dwordx2 v[8:9], v14, s[44:47], 0 offen
    s_mov_b64 exec, s[48:49]
    s_nop 1
    v_add_u32 v6, 8, v3
    v_add_u32 v13, 0, v2
    v_lshrrev_b32 v14, 5, v13
    v_lshlrev_b32 v14, 12, v14
    v_add_u32 v14, 2097152, v14
    v_and_b32 v13, 31, v13
    v_cmp_gt_u32 vcc, 28, v6
    s_and_saveexec_b64 s[48:49], vcc
    v_lshl_add_u32 v14, v13, 4, v14
    v_lshrrev_b32 v12, 3, v6
    v_lshl_add_u32 v14, v12, 9, v14
    v_and_b32 v12, 7, v6
    v_lshl_add_u32 v14, v12, 1, v14
    v_cvt_pk_bf16_f32 v8, v68, v69
    v_cvt_pk_bf16_f32 v9, v70, v71
    v_cmp_eq_u32 vcc, 24, v6
    s_and_saveexec_b64 s[50:51], vcc
    buffer_store_dwordx4 v[8:11], v14, s[44:47], 0 offen
    s_andn2_b64 exec, s[50:51], exec
    buffer_store_dwordx2 v[8:9], v14, s[44:47], 0 offen
    s_mov_b64 exec, s[48:49]
    s_nop 1
    v_add_u32 v13, 32, v2
    v_lshrrev_b32 v14, 5, v13
    v_lshlrev_b32 v14, 12, v14
    v_add_u32 v14, 2097152, v14
    v_and_b32 v13, 31, v13
    v_cmp_gt_u32 vcc, 28, v6
    s_and_saveexec_b64 s[48:49], vcc
    v_lshl_add_u32 v14, v13, 4, v14
    v_lshrrev_b32 v12, 3, v6
    v_lshl_add_u32 v14, v12, 9, v14
    v_and_b32 v12, 7, v6
    v_lshl_add_u32 v14, v12, 1, v14
    v_cvt_pk_bf16_f32 v8, v84, v85
    v_cvt_pk_bf16_f32 v9, v86, v87
    v_cmp_eq_u32 vcc, 24, v6
    s_and_saveexec_b64 s[50:51], vcc
    buffer_store_dwordx4 v[8:11], v14, s[44:47], 0 offen
    s_andn2_b64 exec, s[50:51], exec
    buffer_store_dwordx2 v[8:9], v14, s[44:47], 0 offen
    s_mov_b64 exec, s[48:49]
    s_nop 1
    v_add_u32 v6, 16, v3
    v_add_u32 v13, 0, v2
    v_lshrrev_b32 v14, 5, v13
    v_lshlrev_b32 v14, 12, v14
    v_add_u32 v14, 2097152, v14
    v_and_b32 v13, 31, v13
    v_cmp_gt_u32 vcc, 28, v6
    s_and_saveexec_b64 s[48:49], vcc
    v_lshl_add_u32 v14, v13, 4, v14
    v_lshrrev_b32 v12, 3, v6
    v_lshl_add_u32 v14, v12, 9, v14
    v_and_b32 v12, 7, v6
    v_lshl_add_u32 v14, v12, 1, v14
    v_cvt_pk_bf16_f32 v8, v72, v73
    v_cvt_pk_bf16_f32 v9, v74, v75
    v_cmp_eq_u32 vcc, 24, v6
    s_and_saveexec_b64 s[50:51], vcc
    buffer_store_dwordx4 v[8:11], v14, s[44:47], 0 offen
    s_andn2_b64 exec, s[50:51], exec
    buffer_store_dwordx2 v[8:9], v14, s[44:47], 0 offen
    s_mov_b64 exec, s[48:49]
    s_nop 1
    v_add_u32 v13, 32, v2
    v_lshrrev_b32 v14, 5, v13
    v_lshlrev_b32 v14, 12, v14
    v_add_u32 v14, 2097152, v14
    v_and_b32 v13, 31, v13
    v_cmp_gt_u32 vcc, 28, v6
    s_and_saveexec_b64 s[48:49], vcc
    v_lshl_add_u32 v14, v13, 4, v14
    v_lshrrev_b32 v12, 3, v6
    v_lshl_add_u32 v14, v12, 9, v14
    v_and_b32 v12, 7, v6
    v_lshl_add_u32 v14, v12, 1, v14
    v_cvt_pk_bf16_f32 v8, v88, v89
    v_cvt_pk_bf16_f32 v9, v90, v91
    v_cmp_eq_u32 vcc, 24, v6
    s_and_saveexec_b64 s[50:51], vcc
    buffer_store_dwordx4 v[8:11], v14, s[44:47], 0 offen
    s_andn2_b64 exec, s[50:51], exec
    buffer_store_dwordx2 v[8:9], v14, s[44:47], 0 offen
    s_mov_b64 exec, s[48:49]
    s_nop 1
    v_add_u32 v6, 24, v3
    v_add_u32 v13, 0, v2
    v_lshrrev_b32 v14, 5, v13
    v_lshlrev_b32 v14, 12, v14
    v_add_u32 v14, 2097152, v14
    v_and_b32 v13, 31, v13
    v_cmp_gt_u32 vcc, 28, v6
    s_and_saveexec_b64 s[48:49], vcc
    v_lshl_add_u32 v14, v13, 4, v14
    v_lshrrev_b32 v12, 3, v6
    v_lshl_add_u32 v14, v12, 9, v14
    v_and_b32 v12, 7, v6
    v_lshl_add_u32 v14, v12, 1, v14
    v_cvt_pk_bf16_f32 v8, v76, v77
    v_cvt_pk_bf16_f32 v9, v78, v79
    v_cmp_eq_u32 vcc, 24, v6
    s_and_saveexec_b64 s[50:51], vcc
    buffer_store_dwordx4 v[8:11], v14, s[44:47], 0 offen
    s_andn2_b64 exec, s[50:51], exec
    buffer_store_dwordx2 v[8:9], v14, s[44:47], 0 offen
    s_mov_b64 exec, s[48:49]
    s_nop 1
    v_add_u32 v13, 32, v2
    v_lshrrev_b32 v14, 5, v13
    v_lshlrev_b32 v14, 12, v14
    v_add_u32 v14, 2097152, v14
    v_and_b32 v13, 31, v13
    v_cmp_gt_u32 vcc, 28, v6
    s_and_saveexec_b64 s[48:49], vcc
    v_lshl_add_u32 v14, v13, 4, v14
    v_lshrrev_b32 v12, 3, v6
    v_lshl_add_u32 v14, v12, 9, v14
    v_and_b32 v12, 7, v6
    v_lshl_add_u32 v14, v12, 1, v14
    v_cvt_pk_bf16_f32 v8, v92, v93
    v_cvt_pk_bf16_f32 v9, v94, v95
    v_cmp_eq_u32 vcc, 24, v6
    s_and_saveexec_b64 s[50:51], vcc
    buffer_store_dwordx4 v[8:11], v14, s[44:47], 0 offen
    s_andn2_b64 exec, s[50:51], exec
    buffer_store_dwordx2 v[8:9], v14, s[44:47], 0 offen
    s_mov_b64 exec, s[48:49]
    s_nop 1
    v_add_u32 v6, 0, v3
    v_add_u32 v13, 0, v2
    v_lshrrev_b32 v14, 5, v13
    v_lshlrev_b32 v14, 12, v14
    v_add_u32 v14, 2097152, v14
    v_and_b32 v13, 31, v13
    v_cmp_gt_u32 vcc, 28, v6
    s_and_saveexec_b64 s[48:49], vcc
    v_lshrrev_b32 v12, 4, v13
    v_lshl_add_u32 v14, v12, 10, v14
    v_bfe_u32 v12, v13, 2, 1
    v_lshl_add_u32 v14, v12, 9, v14
    v_bfe_u32 v12, v13, 3, 1
    v_lshl_add_u32 v14, v12, 3, v14
    v_and_b32 v12, 3, v13
    v_lshl_add_u32 v14, v12, 1, v14
    v_lshl_add_u32 v14, v6, 4, v14
    v_add_u32 v14, 2048, v14
    v_cvt_pk_bf16_f32 v8, v96, v97
    v_cvt_pk_bf16_f32 v9, v98, v99
    buffer_store_short v8, v14, s[44:47], 0 offen
    buffer_store_short_d16_hi v8, v14, s[44:47], 0 offen offset:16
    buffer_store_short v9, v14, s[44:47], 0 offen offset:32
    buffer_store_short_d16_hi v9, v14, s[44:47], 0 offen offset:48
    v_cmp_eq_u32 vcc, 24, v6
    s_and_saveexec_b64 s[50:51], vcc
    buffer_store_short v15, v14, s[44:47], 0 offen offset:64
    buffer_store_short v16, v14, s[44:47], 0 offen offset:80
    buffer_store_short v16, v14, s[44:47], 0 offen offset:96
    buffer_store_short v16, v14, s[44:47], 0 offen offset:112
    s_mov_b64 exec, s[48:49]
    s_nop 1
    v_add_u32 v13, 32, v2
    v_lshrrev_b32 v14, 5, v13
    v_lshlrev_b32 v14, 12, v14
    v_add_u32 v14, 2097152, v14
    v_and_b32 v13, 31, v13
    v_cmp_gt_u32 vcc, 28, v6
    s_and_saveexec_b64 s[48:49], vcc
    v_lshrrev_b32 v12, 4, v13
    v_lshl_add_u32 v14, v12, 10, v14
    v_bfe_u32 v12, v13, 2, 1
    v_lshl_add_u32 v14, v12, 9, v14
    v_bfe_u32 v12, v13, 3, 1
    v_lshl_add_u32 v14, v12, 3, v14
    v_and_b32 v12, 3, v13
    v_lshl_add_u32 v14, v12, 1, v14
    v_lshl_add_u32 v14, v6, 4, v14
    v_add_u32 v14, 2048, v14
    v_cvt_pk_bf16_f32 v8, v112, v113
    v_cvt_pk_bf16_f32 v9, v114, v115
    buffer_store_short v8, v14, s[44:47], 0 offen
    buffer_store_short_d16_hi v8, v14, s[44:47], 0 offen offset:16
    buffer_store_short v9, v14, s[44:47], 0 offen offset:32
    buffer_store_short_d16_hi v9, v14, s[44:47], 0 offen offset:48
    v_cmp_eq_u32 vcc, 24, v6
    s_and_saveexec_b64 s[50:51], vcc
    buffer_store_short v15, v14, s[44:47], 0 offen offset:64
    buffer_store_short v16, v14, s[44:47], 0 offen offset:80
    buffer_store_short v16, v14, s[44:47], 0 offen offset:96
    buffer_store_short v16, v14, s[44:47], 0 offen offset:112
    s_mov_b64 exec, s[48:49]
    s_nop 1
    v_add_u32 v6, 8, v3
    v_add_u32 v13, 0, v2
    v_lshrrev_b32 v14, 5, v13
    v_lshlrev_b32 v14, 12, v14
    v_add_u32 v14, 2097152, v14
    v_and_b32 v13, 31, v13
    v_cmp_gt_u32 vcc, 28, v6
    s_and_saveexec_b64 s[48:49], vcc
    v_lshrrev_b32 v12, 4, v13
    v_lshl_add_u32 v14, v12, 10, v14
    v_bfe_u32 v12, v13, 2, 1
    v_lshl_add_u32 v14, v12, 9, v14
    v_bfe_u32 v12, v13, 3, 1
    v_lshl_add_u32 v14, v12, 3, v14
    v_and_b32 v12, 3, v13
    v_lshl_add_u32 v14, v12, 1, v14
    v_lshl_add_u32 v14, v6, 4, v14
    v_add_u32 v14, 2048, v14
    v_cvt_pk_bf16_f32 v8, v100, v101
    v_cvt_pk_bf16_f32 v9, v102, v103
    buffer_store_short v8, v14, s[44:47], 0 offen
    buffer_store_short_d16_hi v8, v14, s[44:47], 0 offen offset:16
    buffer_store_short v9, v14, s[44:47], 0 offen offset:32
    buffer_store_short_d16_hi v9, v14, s[44:47], 0 offen offset:48
    v_cmp_eq_u32 vcc, 24, v6
    s_and_saveexec_b64 s[50:51], vcc
    buffer_store_short v15, v14, s[44:47], 0 offen offset:64
    buffer_store_short v16, v14, s[44:47], 0 offen offset:80
    buffer_store_short v16, v14, s[44:47], 0 offen offset:96
    buffer_store_short v16, v14, s[44:47], 0 offen offset:112
    s_mov_b64 exec, s[48:49]
    s_nop 1
    v_add_u32 v13, 32, v2
    v_lshrrev_b32 v14, 5, v13
    v_lshlrev_b32 v14, 12, v14
    v_add_u32 v14, 2097152, v14
    v_and_b32 v13, 31, v13
    v_cmp_gt_u32 vcc, 28, v6
    s_and_saveexec_b64 s[48:49], vcc
    v_lshrrev_b32 v12, 4, v13
    v_lshl_add_u32 v14, v12, 10, v14
    v_bfe_u32 v12, v13, 2, 1
    v_lshl_add_u32 v14, v12, 9, v14
    v_bfe_u32 v12, v13, 3, 1
    v_lshl_add_u32 v14, v12, 3, v14
    v_and_b32 v12, 3, v13
    v_lshl_add_u32 v14, v12, 1, v14
    v_lshl_add_u32 v14, v6, 4, v14
    v_add_u32 v14, 2048, v14
    v_cvt_pk_bf16_f32 v8, v116, v117
    v_cvt_pk_bf16_f32 v9, v118, v119
    buffer_store_short v8, v14, s[44:47], 0 offen
    buffer_store_short_d16_hi v8, v14, s[44:47], 0 offen offset:16
    buffer_store_short v9, v14, s[44:47], 0 offen offset:32
    buffer_store_short_d16_hi v9, v14, s[44:47], 0 offen offset:48
    v_cmp_eq_u32 vcc, 24, v6
    s_and_saveexec_b64 s[50:51], vcc
    buffer_store_short v15, v14, s[44:47], 0 offen offset:64
    buffer_store_short v16, v14, s[44:47], 0 offen offset:80
    buffer_store_short v16, v14, s[44:47], 0 offen offset:96
    buffer_store_short v16, v14, s[44:47], 0 offen offset:112
    s_mov_b64 exec, s[48:49]
    s_nop 1
    v_add_u32 v6, 16, v3
    v_add_u32 v13, 0, v2
    v_lshrrev_b32 v14, 5, v13
    v_lshlrev_b32 v14, 12, v14
    v_add_u32 v14, 2097152, v14
    v_and_b32 v13, 31, v13
    v_cmp_gt_u32 vcc, 28, v6
    s_and_saveexec_b64 s[48:49], vcc
    v_lshrrev_b32 v12, 4, v13
    v_lshl_add_u32 v14, v12, 10, v14
    v_bfe_u32 v12, v13, 2, 1
    v_lshl_add_u32 v14, v12, 9, v14
    v_bfe_u32 v12, v13, 3, 1
    v_lshl_add_u32 v14, v12, 3, v14
    v_and_b32 v12, 3, v13
    v_lshl_add_u32 v14, v12, 1, v14
    v_lshl_add_u32 v14, v6, 4, v14
    v_add_u32 v14, 2048, v14
    v_cvt_pk_bf16_f32 v8, v104, v105
    v_cvt_pk_bf16_f32 v9, v106, v107
    buffer_store_short v8, v14, s[44:47], 0 offen
    buffer_store_short_d16_hi v8, v14, s[44:47], 0 offen offset:16
    buffer_store_short v9, v14, s[44:47], 0 offen offset:32
    buffer_store_short_d16_hi v9, v14, s[44:47], 0 offen offset:48
    v_cmp_eq_u32 vcc, 24, v6
    s_and_saveexec_b64 s[50:51], vcc
    buffer_store_short v15, v14, s[44:47], 0 offen offset:64
    buffer_store_short v16, v14, s[44:47], 0 offen offset:80
    buffer_store_short v16, v14, s[44:47], 0 offen offset:96
    buffer_store_short v16, v14, s[44:47], 0 offen offset:112
    s_mov_b64 exec, s[48:49]
    s_nop 1
    v_add_u32 v13, 32, v2
    v_lshrrev_b32 v14, 5, v13
    v_lshlrev_b32 v14, 12, v14
    v_add_u32 v14, 2097152, v14
    v_and_b32 v13, 31, v13
    v_cmp_gt_u32 vcc, 28, v6
    s_and_saveexec_b64 s[48:49], vcc
    v_lshrrev_b32 v12, 4, v13
    v_lshl_add_u32 v14, v12, 10, v14
    v_bfe_u32 v12, v13, 2, 1
    v_lshl_add_u32 v14, v12, 9, v14
    v_bfe_u32 v12, v13, 3, 1
    v_lshl_add_u32 v14, v12, 3, v14
    v_and_b32 v12, 3, v13
    v_lshl_add_u32 v14, v12, 1, v14
    v_lshl_add_u32 v14, v6, 4, v14
    v_add_u32 v14, 2048, v14
    v_cvt_pk_bf16_f32 v8, v120, v121
    v_cvt_pk_bf16_f32 v9, v122, v123
    buffer_store_short v8, v14, s[44:47], 0 offen
    buffer_store_short_d16_hi v8, v14, s[44:47], 0 offen offset:16
    buffer_store_short v9, v14, s[44:47], 0 offen offset:32
    buffer_store_short_d16_hi v9, v14, s[44:47], 0 offen offset:48
    v_cmp_eq_u32 vcc, 24, v6
    s_and_saveexec_b64 s[50:51], vcc
    buffer_store_short v15, v14, s[44:47], 0 offen offset:64
    buffer_store_short v16, v14, s[44:47], 0 offen offset:80
    buffer_store_short v16, v14, s[44:47], 0 offen offset:96
    buffer_store_short v16, v14, s[44:47], 0 offen offset:112
    s_mov_b64 exec, s[48:49]
    s_nop 1
    v_add_u32 v6, 24, v3
    v_add_u32 v13, 0, v2
    v_lshrrev_b32 v14, 5, v13
    v_lshlrev_b32 v14, 12, v14
    v_add_u32 v14, 2097152, v14
    v_and_b32 v13, 31, v13
    v_cmp_gt_u32 vcc, 28, v6
    s_and_saveexec_b64 s[48:49], vcc
    v_lshrrev_b32 v12, 4, v13
    v_lshl_add_u32 v14, v12, 10, v14
    v_bfe_u32 v12, v13, 2, 1
    v_lshl_add_u32 v14, v12, 9, v14
    v_bfe_u32 v12, v13, 3, 1
    v_lshl_add_u32 v14, v12, 3, v14
    v_and_b32 v12, 3, v13
    v_lshl_add_u32 v14, v12, 1, v14
    v_lshl_add_u32 v14, v6, 4, v14
    v_add_u32 v14, 2048, v14
    v_cvt_pk_bf16_f32 v8, v108, v109
    v_cvt_pk_bf16_f32 v9, v110, v111
    buffer_store_short v8, v14, s[44:47], 0 offen
    buffer_store_short_d16_hi v8, v14, s[44:47], 0 offen offset:16
    buffer_store_short v9, v14, s[44:47], 0 offen offset:32
    buffer_store_short_d16_hi v9, v14, s[44:47], 0 offen offset:48
    v_cmp_eq_u32 vcc, 24, v6
    s_and_saveexec_b64 s[50:51], vcc
    buffer_store_short v15, v14, s[44:47], 0 offen offset:64
    buffer_store_short v16, v14, s[44:47], 0 offen offset:80
    buffer_store_short v16, v14, s[44:47], 0 offen offset:96
    buffer_store_short v16, v14, s[44:47], 0 offen offset:112
    s_mov_b64 exec, s[48:49]
    s_nop 1
    v_add_u32 v13, 32, v2
    v_lshrrev_b32 v14, 5, v13
    v_lshlrev_b32 v14, 12, v14
    v_add_u32 v14, 2097152, v14
    v_and_b32 v13, 31, v13
    v_cmp_gt_u32 vcc, 28, v6
    s_and_saveexec_b64 s[48:49], vcc
    v_lshrrev_b32 v12, 4, v13
    v_lshl_add_u32 v14, v12, 10, v14
    v_bfe_u32 v12, v13, 2, 1
    v_lshl_add_u32 v14, v12, 9, v14
    v_bfe_u32 v12, v13, 3, 1
    v_lshl_add_u32 v14, v12, 3, v14
    v_and_b32 v12, 3, v13
    v_lshl_add_u32 v14, v12, 1, v14
    v_lshl_add_u32 v14, v6, 4, v14
    v_add_u32 v14, 2048, v14
    v_cvt_pk_bf16_f32 v8, v124, v125
    v_cvt_pk_bf16_f32 v9, v126, v127
    buffer_store_short v8, v14, s[44:47], 0 offen
    buffer_store_short_d16_hi v8, v14, s[44:47], 0 offen offset:16
    buffer_store_short v9, v14, s[44:47], 0 offen offset:32
    buffer_store_short_d16_hi v9, v14, s[44:47], 0 offen offset:48
    v_cmp_eq_u32 vcc, 24, v6
    s_and_saveexec_b64 s[50:51], vcc
    buffer_store_short v15, v14, s[44:47], 0 offen offset:64
    buffer_store_short v16, v14, s[44:47], 0 offen offset:80
    buffer_store_short v16, v14, s[44:47], 0 offen offset:96
    buffer_store_short v16, v14, s[44:47], 0 offen offset:112
    s_mov_b64 exec, s[48:49]
    s_nop 1
    s_endpgm
K1_B:
    s_mov_b32 s24, s12
    s_and_b32 s25, s13, 0xffff
    s_mov_b32 s26, 1835008
    s_mov_b32 s27, 0x20000
    s_mov_b32 s28, s14
    s_and_b32 s29, s15, 0xffff
    s_mov_b32 s30, 1204224
    s_mov_b32 s31, 0x20000
    s_mov_b32 s33, 2688
    s_sub_u32 s3, s3, 5
    s_lshl_b32 s34, s3, 8
    v_lshrrev_b32 v12, 3, v0
    v_and_b32 v13, 7, v0
    v_mul_u32_u24 v2, 896, v12
    v_lshl_add_u32 v2, v13, 4, v2
    v_add_u32 v2, s32, v2
    v_add_u32 v3, 28672, v2
    v_add_u32 v4, 57344, v2
    v_add_u32 v5, 86016, v2
    v_mul_u32_u24 v10, 144, v12
    v_lshl_add_u32 v10, v13, 4, v10
    v_lshrrev_b32 v12, 4, v0
    v_and_b32 v13, 15, v0
    v_mul_lo_u32 v6, s33, v12
    v_lshl_add_u32 v6, v13, 4, v6
    v_add_u32 v6, s34, v6
    s_mul_i32 s35, s33, 16
    v_add_u32 v7, s35, v6
    v_add_u32 v8, s35, v7
    v_add_u32 v9, s35, v8
    v_mul_u32_u24 v11, 320, v12
    v_lshl_add_u32 v11, v13, 4, v11
    v_add_u32 v11, 18432, v11
    v_and_b32 v12, 31, v1
    v_lshrrev_b32 v13, 5, v1
    s_lshl_b32 s35, s36, 6
    v_add_u32 v12, s35, v12
    v_mul_u32_u24 v52, 144, v12
    v_lshl_add_u32 v52, v13, 4, v52
    v_bfe_u32 v12, v1, 2, 2
    v_lshl_add_u32 v12, v13, 3, v12
    v_mul_u32_u24 v53, 320, v12
    v_bfe_u32 v12, v1, 4, 1
    v_and_b32 v13, 3, v1
    v_lshlrev_b32 v12, 5, v12
    v_lshl_add_u32 v12, v13, 3, v12
    v_add_u32 v53, v53, v12
    s_mul_i32 s35, s37, 128
    v_add_u32 v53, s35, v53
    v_add_u32 v53, 18432, v53
    v_mov_b32 v64, 0
    v_mov_b32 v65, 0
    v_mov_b32 v66, 0
    v_mov_b32 v67, 0
    v_mov_b32 v68, 0
    v_mov_b32 v69, 0
    v_mov_b32 v70, 0
    v_mov_b32 v71, 0
    v_mov_b32 v72, 0
    v_mov_b32 v73, 0
    v_mov_b32 v74, 0
    v_mov_b32 v75, 0
    v_mov_b32 v76, 0
    v_mov_b32 v77, 0
    v_mov_b32 v78, 0
    v_mov_b32 v79, 0
    v_mov_b32 v80, 0
    v_mov_b32 v81, 0
    v_mov_b32 v82, 0
    v_mov_b32 v83, 0
    v_mov_b32 v84, 0
    v_mov_b32 v85, 0
    v_mov_b32 v86, 0
    v_mov_b32 v87, 0
    v_mov_b32 v88, 0
    v_mov_b32 v89, 0
    v_mov_b32 v90, 0
    v_mov_b32 v91, 0
    v_mov_b32 v92, 0
    v_mov_b32 v93, 0
    v_mov_b32 v94, 0
    v_mov_b32 v95, 0
    v_mov_b32 v96, 0
    v_mov_b32 v97, 0
    v_mov_b32 v98, 0
    v_mov_b32 v99, 0
    v_mov_b32 v100, 0
    v_mov_b32 v101, 0
    v_mov_b32 v102, 0
    v_mov_b32 v103, 0
    v_mov_b32 v104, 0
    v_mov_b32 v105, 0
    v_mov_b32 v106, 0
    v_mov_b32 v107, 0
    v_mov_b32 v108, 0
    v_mov_b32 v109, 0
    v_mov_b32 v110, 0
    v_mov_b32 v111, 0
    v_mov_b32 v112, 0
    v_mov_b32 v113, 0
    v_mov_b32 v114, 0
    v_mov_b32 v115, 0
    v_mov_b32 v116, 0
    v_mov_b32 v117, 0
    v_mov_b32 v118, 0
    v_mov_b32 v119, 0
    v_mov_b32 v120, 0
    v_mov_b32 v121, 0
    v_mov_b32 v122, 0
    v_mov_b32 v123, 0
    v_mov_b32 v124, 0
    v_mov_b32 v125, 0
    v_mov_b32 v126, 0
    v_mov_b32 v127, 0
    s_mov_b32 s38, 0
    buffer_load_dwordx4 v[16:19], v2, s[24:27], s38 offen
    buffer_load_dwordx4 v[20:23], v3, s[24:27], s38 offen
    buffer_load_dwordx4 v[24:27], v4, s[24:27], s38 offen
    buffer_load_dwordx4 v[28:31], v5, s[24:27], s38 offen
    s_mul_i32 s38, s33, 0
    buffer_load_dwordx4 v[32:35], v6, s[28:31], s38 offen
    buffer_load_dwordx4 v[36:39], v7, s[28:31], s38 offen
    buffer_load_dwordx4 v[40:43], v8, s[28:31], s38 offen
    buffer_load_dwordx4 v[44:47], v9, s[28:31], s38 offen
    s_mov_b32 s38, 128
    buffer_load_dwordx4 v[144:147], v2, s[24:27], s38 offen
    buffer_load_dwordx4 v[148:151], v3, s[24:27], s38 offen
    buffer_load_dwordx4 v[152:155], v4, s[24:27], s38 offen
    buffer_load_dwordx4 v[156:159], v5, s[24:27], s38 offen
    s_mul_i32 s38, s33, 64
    buffer_load_dwordx4 v[160:163], v6, s[28:31], s38 offen
    buffer_load_dwordx4 v[164:167], v7, s[28:31], s38 offen
    buffer_load_dwordx4 v[168:171], v8, s[28:31], s38 offen
    buffer_load_dwordx4 v[172:175], v9, s[28:31], s38 offen
    s_waitcnt vmcnt(8)
    ds_write_b128 v10, v[16:19] offset:0
    ds_write_b128 v10, v[20:23] offset:4608
    ds_write_b128 v10, v[24:27] offset:9216
    ds_write_b128 v10, v[28:31] offset:13824
    ds_write_b128 v11, v[32:35] offset:0
    ds_write_b128 v11, v[36:39] offset:5120
    ds_write_b128 v11, v[40:43] offset:10240
    ds_write_b128 v11, v[44:47] offset:15360
    s_waitcnt lgkmcnt(0)
    s_barrier
    s_mov_b32 s38, 256
    buffer_load_dwordx4 v[16:19], v2, s[24:27], s38 offen
    buffer_load_dwordx4 v[20:23], v3, s[24:27], s38 offen
    buffer_load_dwordx4 v[24:27], v4, s[24:27], s38 offen
    buffer_load_dwordx4 v[28:31], v5, s[24:27], s38 offen
    s_mul_i32 s38, s33, 128
    buffer_load_dwordx4 v[32:35], v6, s[28:31], s38 offen
    buffer_load_dwordx4 v[36:39], v7, s[28:31], s38 offen
    buffer_load_dwordx4 v[40:43], v8, s[28:31], s38 offen
    buffer_load_dwordx4 v[44:47], v9, s[28:31], s38 offen
    ds_read_b128 v[128:131], v52 offset:0
    ds_read_b128 v[132:135], v52 offset:4608
    ds_read_b64_tr_b16 v[136:137], v53 offset:0
    ds_read_b64_tr_b16 v[138:139], v53 offset:1280
    ds_read_b64_tr_b16 v[140:141], v53 offset:64
    ds_read_b64_tr_b16 v[142:143], v53 offset:1344
    s_waitcnt lgkmcnt(0)
    v_mfma_f32_32x32x16_bf16 v[64:79], v[136:139], v[128:131], v[64:79]
    v_mfma_f32_32x32x16_bf16 v[80:95], v[136:139], v[132:135], v[80:95]
    v_mfma_f32_32x32x16_bf16 v[96:111], v[140:143], v[128:131], v[96:111]
    v_mfma_f32_32x32x16_bf16 v[112:127], v[140:143], v[132:135], v[112:127]
    ds_read_b128 v[128:131], v52 offset:32
    ds_read_b128 v[132:135], v52 offset:4640
    ds_read_b64_tr_b16 v[136:137], v53 offset:5120
    ds_read_b64_tr_b16 v[138:139], v53 offset:6400
    ds_read_b64_tr_b16 v[140:141], v53 offset:5184
    ds_read_b64_tr_b16 v[142:143], v53 offset:6464
    s_waitcnt lgkmcnt(0)
    v_mfma_f32_32x32x16_bf16 v[64:79], v[136:139], v[128:131], v[64:79]
    v_mfma_f32_32x32x16_bf16 v[80:95], v[136:139], v[132:135], v[80:95]
    v_mfma_f32_32x32x16_bf16 v[96:111], v[140:143], v[128:131], v[96:111]
    v_mfma_f32_32x32x16_bf16 v[112:127], v[140:143], v[132:135], v[112:127]
    ds_read_b128 v[128:131], v52 offset:64
    ds_read_b128 v[132:135], v52 offset:4672
    ds_read_b64_tr_b16 v[136:137], v53 offset:10240
    ds_read_b64_tr_b16 v[138:139], v53 offset:11520
    ds_read_b64_tr_b16 v[140:141], v53 offset:10304
    ds_read_b64_tr_b16 v[142:143], v53 offset:11584
    s_waitcnt lgkmcnt(0)
    v_mfma_f32_32x32x16_bf16 v[64:79], v[136:139], v[128:131], v[64:79]
    v_mfma_f32_32x32x16_bf16 v[80:95], v[136:139], v[132:135], v[80:95]
    v_mfma_f32_32x32x16_bf16 v[96:111], v[140:143], v[128:131], v[96:111]
    v_mfma_f32_32x32x16_bf16 v[112:127], v[140:143], v[132:135], v[112:127]
    ds_read_b128 v[128:131], v52 offset:96
    ds_read_b128 v[132:135], v52 offset:4704
    ds_read_b64_tr_b16 v[136:137], v53 offset:15360
    ds_read_b64_tr_b16 v[138:139], v53 offset:16640
    ds_read_b64_tr_b16 v[140:141], v53 offset:15424
    ds_read_b64_tr_b16 v[142:143], v53 offset:16704
    s_waitcnt lgkmcnt(0)
    v_mfma_f32_32x32x16_bf16 v[64:79], v[136:139], v[128:131], v[64:79]
    v_mfma_f32_32x32x16_bf16 v[80:95], v[136:139], v[132:135], v[80:95]
    v_mfma_f32_32x32x16_bf16 v[96:111], v[140:143], v[128:131], v[96:111]
    v_mfma_f32_32x32x16_bf16 v[112:127], v[140:143], v[132:135], v[112:127]
    s_waitcnt vmcnt(8)
    ds_write_b128 v10, v[144:147] offset:38912
    ds_write_b128 v10, v[148:151] offset:43520
    ds_write_b128 v10, v[152:155] offset:48128
    ds_write_b128 v10, v[156:159] offset:52736
    ds_write_b128 v11, v[160:163] offset:38912
    ds_write_b128 v11, v[164:167] offset:44032
    ds_write_b128 v11, v[168:171] offset:49152
    ds_write_b128 v11, v[172:175] offset:54272
    s_waitcnt lgkmcnt(0)
    s_barrier
    s_mov_b32 s38, 384
    buffer_load_dwordx4 v[144:147], v2, s[24:27], s38 offen
    buffer_load_dwordx4 v[148:151], v3, s[24:27], s38 offen
    buffer_load_dwordx4 v[152:155], v4, s[24:27], s38 offen
    buffer_load_dwordx4 v[156:159], v5, s[24:27], s38 offen
    s_mul_i32 s38, s33, 192
    buffer_load_dwordx4 v[160:163], v6, s[28:31], s38 offen
    buffer_load_dwordx4 v[164:167], v7, s[28:31], s38 offen
    buffer_load_dwordx4 v[168:171], v8, s[28:31], s38 offen
    buffer_load_dwordx4 v[172:175], v9, s[28:31], s38 offen
    ds_read_b128 v[128:131], v52 offset:38912
    ds_read_b128 v[132:135], v52 offset:43520
    ds_read_b64_tr_b16 v[136:137], v53 offset:38912
    ds_read_b64_tr_b16 v[138:139], v53 offset:40192
    ds_read_b64_tr_b16 v[140:141], v53 offset:38976
    ds_read_b64_tr_b16 v[142:143], v53 offset:40256
    s_waitcnt lgkmcnt(0)
    v_mfma_f32_32x32x16_bf16 v[64:79], v[136:139], v[128:131], v[64:79]
    v_mfma_f32_32x32x16_bf16 v[80:95], v[136:139], v[132:135], v[80:95]
    v_mfma_f32_32x32x16_bf16 v[96:111], v[140:143], v[128:131], v[96:111]
    v_mfma_f32_32x32x16_bf16 v[112:127], v[140:143], v[132:135], v[112:127]
    ds_read_b128 v[128:131], v52 offset:38944
    ds_read_b128 v[132:135], v52 offset:43552
    ds_read_b64_tr_b16 v[136:137], v53 offset:44032
    ds_read_b64_tr_b16 v[138:139], v53 offset:45312
    ds_read_b64_tr_b16 v[140:141], v53 offset:44096
    ds_read_b64_tr_b16 v[142:143], v53 offset:45376
    s_waitcnt lgkmcnt(0)
    v_mfma_f32_32x32x16_bf16 v[64:79], v[136:139], v[128:131], v[64:79]
    v_mfma_f32_32x32x16_bf16 v[80:95], v[136:139], v[132:135], v[80:95]
    v_mfma_f32_32x32x16_bf16 v[96:111], v[140:143], v[128:131], v[96:111]
    v_mfma_f32_32x32x16_bf16 v[112:127], v[140:143], v[132:135], v[112:127]
    ds_read_b128 v[128:131], v52 offset:38976
    ds_read_b128 v[132:135], v52 offset:43584
    ds_read_b64_tr_b16 v[136:137], v53 offset:49152
    ds_read_b64_tr_b16 v[138:139], v53 offset:50432
    ds_read_b64_tr_b16 v[140:141], v53 offset:49216
    ds_read_b64_tr_b16 v[142:143], v53 offset:50496
    s_waitcnt lgkmcnt(0)
    v_mfma_f32_32x32x16_bf16 v[64:79], v[136:139], v[128:131], v[64:79]
    v_mfma_f32_32x32x16_bf16 v[80:95], v[136:139], v[132:135], v[80:95]
    v_mfma_f32_32x32x16_bf16 v[96:111], v[140:143], v[128:131], v[96:111]
    v_mfma_f32_32x32x16_bf16 v[112:127], v[140:143], v[132:135], v[112:127]
    ds_read_b128 v[128:131], v52 offset:39008
    ds_read_b128 v[132:135], v52 offset:43616
    ds_read_b64_tr_b16 v[136:137], v53 offset:54272
    ds_read_b64_tr_b16 v[138:139], v53 offset:55552
    ds_read_b64_tr_b16 v[140:141], v53 offset:54336
    ds_read_b64_tr_b16 v[142:143], v53 offset:55616
    s_waitcnt lgkmcnt(0)
    v_mfma_f32_32x32x16_bf16 v[64:79], v[136:139], v[128:131], v[64:79]
    v_mfma_f32_32x32x16_bf16 v[80:95], v[136:139], v[132:135], v[80:95]
    v_mfma_f32_32x32x16_bf16 v[96:111], v[140:143], v[128:131], v[96:111]
    v_mfma_f32_32x32x16_bf16 v[112:127], v[140:143], v[132:135], v[112:127]
    s_waitcnt vmcnt(8)
    ds_write_b128 v10, v[16:19] offset:0
    ds_write_b128 v10, v[20:23] offset:4608
    ds_write_b128 v10, v[24:27] offset:9216
    ds_write_b128 v10, v[28:31] offset:13824
    ds_write_b128 v11, v[32:35] offset:0
    ds_write_b128 v11, v[36:39] offset:5120
    ds_write_b128 v11, v[40:43] offset:10240
    ds_write_b128 v11, v[44:47] offset:15360
    s_waitcnt lgkmcnt(0)
    s_barrier
    s_mov_b32 s38, 512
    buffer_load_dwordx4 v[16:19], v2, s[24:27], s38 offen
    buffer_load_dwordx4 v[20:23], v3, s[24:27], s38 offen
    buffer_load_dwordx4 v[24:27], v4, s[24:27], s38 offen
    buffer_load_dwordx4 v[28:31], v5, s[24:27], s38 offen
    s_mul_i32 s38, s33, 256
    buffer_load_dwordx4 v[32:35], v6, s[28:31], s38 offen
    buffer_load_dwordx4 v[36:39], v7, s[28:31], s38 offen
    buffer_load_dwordx4 v[40:43], v8, s[28:31], s38 offen
    buffer_load_dwordx4 v[44:47], v9, s[28:31], s38 offen
    ds_read_b128 v[128:131], v52 offset:0
    ds_read_b128 v[132:135], v52 offset:4608
    ds_read_b64_tr_b16 v[136:137], v53 offset:0
    ds_read_b64_tr_b16 v[138:139], v53 offset:1280
    ds_read_b64_tr_b16 v[140:141], v53 offset:64
    ds_read_b64_tr_b16 v[142:143], v53 offset:1344
    s_waitcnt lgkmcnt(0)
    v_mfma_f32_32x32x16_bf16 v[64:79], v[136:139], v[128:131], v[64:79]
    v_mfma_f32_32x32x16_bf16 v[80:95], v[136:139], v[132:135], v[80:95]
    v_mfma_f32_32x32x16_bf16 v[96:111], v[140:143], v[128:131], v[96:111]
    v_mfma_f32_32x32x16_bf16 v[112:127], v[140:143], v[132:135], v[112:127]
    ds_read_b128 v[128:131], v52 offset:32
    ds_read_b128 v[132:135], v52 offset:4640
    ds_read_b64_tr_b16 v[136:137], v53 offset:5120
    ds_read_b64_tr_b16 v[138:139], v53 offset:6400
    ds_read_b64_tr_b16 v[140:141], v53 offset:5184
    ds_read_b64_tr_b16 v[142:143], v53 offset:6464
    s_waitcnt lgkmcnt(0)
    v_mfma_f32_32x32x16_bf16 v[64:79], v[136:139], v[128:131], v[64:79]
    v_mfma_f32_32x32x16_bf16 v[80:95], v[136:139], v[132:135], v[80:95]
    v_mfma_f32_32x32x16_bf16 v[96:111], v[140:143], v[128:131], v[96:111]
    v_mfma_f32_32x32x16_bf16 v[112:127], v[140:143], v[132:135], v[112:127]
    ds_read_b128 v[128:131], v52 offset:64
    ds_read_b128 v[132:135], v52 offset:4672
    ds_read_b64_tr_b16 v[136:137], v53 offset:10240
    ds_read_b64_tr_b16 v[138:139], v53 offset:11520
    ds_read_b64_tr_b16 v[140:141], v53 offset:10304
    ds_read_b64_tr_b16 v[142:143], v53 offset:11584
    s_waitcnt lgkmcnt(0)
    v_mfma_f32_32x32x16_bf16 v[64:79], v[136:139], v[128:131], v[64:79]
    v_mfma_f32_32x32x16_bf16 v[80:95], v[136:139], v[132:135], v[80:95]
    v_mfma_f32_32x32x16_bf16 v[96:111], v[140:143], v[128:131], v[96:111]
    v_mfma_f32_32x32x16_bf16 v[112:127], v[140:143], v[132:135], v[112:127]
    ds_read_b128 v[128:131], v52 offset:96
    ds_read_b128 v[132:135], v52 offset:4704
    ds_read_b64_tr_b16 v[136:137], v53 offset:15360
    ds_read_b64_tr_b16 v[138:139], v53 offset:16640
    ds_read_b64_tr_b16 v[140:141], v53 offset:15424
    ds_read_b64_tr_b16 v[142:143], v53 offset:16704
    s_waitcnt lgkmcnt(0)
    v_mfma_f32_32x32x16_bf16 v[64:79], v[136:139], v[128:131], v[64:79]
    v_mfma_f32_32x32x16_bf16 v[80:95], v[136:139], v[132:135], v[80:95]
    v_mfma_f32_32x32x16_bf16 v[96:111], v[140:143], v[128:131], v[96:111]
    v_mfma_f32_32x32x16_bf16 v[112:127], v[140:143], v[132:135], v[112:127]
    s_waitcnt vmcnt(8)
    ds_write_b128 v10, v[144:147] offset:38912
    ds_write_b128 v10, v[148:151] offset:43520
    ds_write_b128 v10, v[152:155] offset:48128
    ds_write_b128 v10, v[156:159] offset:52736
    ds_write_b128 v11, v[160:163] offset:38912
    ds_write_b128 v11, v[164:167] offset:44032
    ds_write_b128 v11, v[168:171] offset:49152
    ds_write_b128 v11, v[172:175] offset:54272
    s_waitcnt lgkmcnt(0)
    s_barrier
    s_mov_b32 s38, 640
    buffer_load_dwordx4 v[144:147], v2, s[24:27], s38 offen
    buffer_load_dwordx4 v[148:151], v3, s[24:27], s38 offen
    buffer_load_dwordx4 v[152:155], v4, s[24:27], s38 offen
    buffer_load_dwordx4 v[156:159], v5, s[24:27], s38 offen
    s_mul_i32 s38, s33, 320
    buffer_load_dwordx4 v[160:163], v6, s[28:31], s38 offen
    buffer_load_dwordx4 v[164:167], v7, s[28:31], s38 offen
    buffer_load_dwordx4 v[168:171], v8, s[28:31], s38 offen
    buffer_load_dwordx4 v[172:175], v9, s[28:31], s38 offen
    ds_read_b128 v[128:131], v52 offset:38912
    ds_read_b128 v[132:135], v52 offset:43520
    ds_read_b64_tr_b16 v[136:137], v53 offset:38912
    ds_read_b64_tr_b16 v[138:139], v53 offset:40192
    ds_read_b64_tr_b16 v[140:141], v53 offset:38976
    ds_read_b64_tr_b16 v[142:143], v53 offset:40256
    s_waitcnt lgkmcnt(0)
    v_mfma_f32_32x32x16_bf16 v[64:79], v[136:139], v[128:131], v[64:79]
    v_mfma_f32_32x32x16_bf16 v[80:95], v[136:139], v[132:135], v[80:95]
    v_mfma_f32_32x32x16_bf16 v[96:111], v[140:143], v[128:131], v[96:111]
    v_mfma_f32_32x32x16_bf16 v[112:127], v[140:143], v[132:135], v[112:127]
    ds_read_b128 v[128:131], v52 offset:38944
    ds_read_b128 v[132:135], v52 offset:43552
    ds_read_b64_tr_b16 v[136:137], v53 offset:44032
    ds_read_b64_tr_b16 v[138:139], v53 offset:45312
    ds_read_b64_tr_b16 v[140:141], v53 offset:44096
    ds_read_b64_tr_b16 v[142:143], v53 offset:45376
    s_waitcnt lgkmcnt(0)
    v_mfma_f32_32x32x16_bf16 v[64:79], v[136:139], v[128:131], v[64:79]
    v_mfma_f32_32x32x16_bf16 v[80:95], v[136:139], v[132:135], v[80:95]
    v_mfma_f32_32x32x16_bf16 v[96:111], v[140:143], v[128:131], v[96:111]
    v_mfma_f32_32x32x16_bf16 v[112:127], v[140:143], v[132:135], v[112:127]
    ds_read_b128 v[128:131], v52 offset:38976
    ds_read_b128 v[132:135], v52 offset:43584
    ds_read_b64_tr_b16 v[136:137], v53 offset:49152
    ds_read_b64_tr_b16 v[138:139], v53 offset:50432
    ds_read_b64_tr_b16 v[140:141], v53 offset:49216
    ds_read_b64_tr_b16 v[142:143], v53 offset:50496
    s_waitcnt lgkmcnt(0)
    v_mfma_f32_32x32x16_bf16 v[64:79], v[136:139], v[128:131], v[64:79]
    v_mfma_f32_32x32x16_bf16 v[80:95], v[136:139], v[132:135], v[80:95]
    v_mfma_f32_32x32x16_bf16 v[96:111], v[140:143], v[128:131], v[96:111]
    v_mfma_f32_32x32x16_bf16 v[112:127], v[140:143], v[132:135], v[112:127]
    ds_read_b128 v[128:131], v52 offset:39008
    ds_read_b128 v[132:135], v52 offset:43616
    ds_read_b64_tr_b16 v[136:137], v53 offset:54272
    ds_read_b64_tr_b16 v[138:139], v53 offset:55552
    ds_read_b64_tr_b16 v[140:141], v53 offset:54336
    ds_read_b64_tr_b16 v[142:143], v53 offset:55616
    s_waitcnt lgkmcnt(0)
    v_mfma_f32_32x32x16_bf16 v[64:79], v[136:139], v[128:131], v[64:79]
    v_mfma_f32_32x32x16_bf16 v[80:95], v[136:139], v[132:135], v[80:95]
    v_mfma_f32_32x32x16_bf16 v[96:111], v[140:143], v[128:131], v[96:111]
    v_mfma_f32_32x32x16_bf16 v[112:127], v[140:143], v[132:135], v[112:127]
    s_waitcnt vmcnt(8)
    ds_write_b128 v10, v[16:19] offset:0
    ds_write_b128 v10, v[20:23] offset:4608
    ds_write_b128 v10, v[24:27] offset:9216
    ds_write_b128 v10, v[28:31] offset:13824
    ds_write_b128 v11, v[32:35] offset:0
    ds_write_b128 v11, v[36:39] offset:5120
    ds_write_b128 v11, v[40:43] offset:10240
    ds_write_b128 v11, v[44:47] offset:15360
    s_waitcnt lgkmcnt(0)
    s_barrier
    s_mov_b32 s38, 768
    buffer_load_dwordx4 v[16:19], v2, s[24:27], s38 offen
    buffer_load_dwordx4 v[20:23], v3, s[24:27], s38 offen
    buffer_load_dwordx4 v[24:27], v4, s[24:27], s38 offen
    buffer_load_dwordx4 v[28:31], v5, s[24:27], s38 offen
    s_mul_i32 s38, s33, 384
    buffer_load_dwordx4 v[32:35], v6, s[28:31], s38 offen
    buffer_load_dwordx4 v[36:39], v7, s[28:31], s38 offen
    buffer_load_dwordx4 v[40:43], v8, s[28:31], s38 offen
    buffer_load_dwordx4 v[44:47], v9, s[28:31], s38 offen
    ds_read_b128 v[128:131], v52 offset:0
    ds_read_b128 v[132:135], v52 offset:4608
    ds_read_b64_tr_b16 v[136:137], v53 offset:0
    ds_read_b64_tr_b16 v[138:139], v53 offset:1280
    ds_read_b64_tr_b16 v[140:141], v53 offset:64
    ds_read_b64_tr_b16 v[142:143], v53 offset:1344
    s_waitcnt lgkmcnt(0)
    v_mfma_f32_32x32x16_bf16 v[64:79], v[136:139], v[128:131], v[64:79]
    v_mfma_f32_32x32x16_bf16 v[80:95], v[136:139], v[132:135], v[80:95]
    v_mfma_f32_32x32x16_bf16 v[96:111], v[140:143], v[128:131], v[96:111]
    v_mfma_f32_32x32x16_bf16 v[112:127], v[140:143], v[132:135], v[112:127]
    ds_read_b128 v[128:131], v52 offset:32
    ds_read_b128 v[132:135], v52 offset:4640
    ds_read_b64_tr_b16 v[136:137], v53 offset:5120
    ds_read_b64_tr_b16 v[138:139], v53 offset:6400
    ds_read_b64_tr_b16 v[140:141], v53 offset:5184
    ds_read_b64_tr_b16 v[142:143], v53 offset:6464
    s_waitcnt lgkmcnt(0)
    v_mfma_f32_32x32x16_bf16 v[64:79], v[136:139], v[128:131], v[64:79]
    v_mfma_f32_32x32x16_bf16 v[80:95], v[136:139], v[132:135], v[80:95]
    v_mfma_f32_32x32x16_bf16 v[96:111], v[140:143], v[128:131], v[96:111]
    v_mfma_f32_32x32x16_bf16 v[112:127], v[140:143], v[132:135], v[112:127]
    ds_read_b128 v[128:131], v52 offset:64
    ds_read_b128 v[132:135], v52 offset:4672
    ds_read_b64_tr_b16 v[136:137], v53 offset:10240
    ds_read_b64_tr_b16 v[138:139], v53 offset:11520
    ds_read_b64_tr_b16 v[140:141], v53 offset:10304
    ds_read_b64_tr_b16 v[142:143], v53 offset:11584
    s_waitcnt lgkmcnt(0)
    v_mfma_f32_32x32x16_bf16 v[64:79], v[136:139], v[128:131], v[64:79]
    v_mfma_f32_32x32x16_bf16 v[80:95], v[136:139], v[132:135], v[80:95]
    v_mfma_f32_32x32x16_bf16 v[96:111], v[140:143], v[128:131], v[96:111]
    v_mfma_f32_32x32x16_bf16 v[112:127], v[140:143], v[132:135], v[112:127]
    ds_read_b128 v[128:131], v52 offset:96
    ds_read_b128 v[132:135], v52 offset:4704
    ds_read_b64_tr_b16 v[136:137], v53 offset:15360
    ds_read_b64_tr_b16 v[138:139], v53 offset:16640
    ds_read_b64_tr_b16 v[140:141], v53 offset:15424
    ds_read_b64_tr_b16 v[142:143], v53 offset:16704
    s_waitcnt lgkmcnt(0)
    v_mfma_f32_32x32x16_bf16 v[64:79], v[136:139], v[128:131], v[64:79]
    v_mfma_f32_32x32x16_bf16 v[80:95], v[136:139], v[132:135], v[80:95]
    v_mfma_f32_32x32x16_bf16 v[96:111], v[140:143], v[128:131], v[96:111]
    v_mfma_f32_32x32x16_bf16 v[112:127], v[140:143], v[132:135], v[112:127]
    s_waitcnt vmcnt(8)
    ds_write_b128 v10, v[144:147] offset:38912
    ds_write_b128 v10, v[148:151] offset:43520
    ds_write_b128 v10, v[152:155] offset:48128
    ds_write_b128 v10, v[156:159] offset:52736
    ds_write_b128 v11, v[160:163] offset:38912
    ds_write_b128 v11, v[164:167] offset:44032
    ds_write_b128 v11, v[168:171] offset:49152
    ds_write_b128 v11, v[172:175] offset:54272
    s_waitcnt lgkmcnt(0)
    s_barrier
    ds_read_b128 v[128:131], v52 offset:38912
    ds_read_b128 v[132:135], v52 offset:43520
    ds_read_b64_tr_b16 v[136:137], v53 offset:38912
    ds_read_b64_tr_b16 v[138:139], v53 offset:40192
    ds_read_b64_tr_b16 v[140:141], v53 offset:38976
    ds_read_b64_tr_b16 v[142:143], v53 offset:40256
    s_waitcnt lgkmcnt(0)
    v_mfma_f32_32x32x16_bf16 v[64:79], v[136:139], v[128:131], v[64:79]
    v_mfma_f32_32x32x16_bf16 v[80:95], v[136:139], v[132:135], v[80:95]
    v_mfma_f32_32x32x16_bf16 v[96:111], v[140:143], v[128:131], v[96:111]
    v_mfma_f32_32x32x16_bf16 v[112:127], v[140:143], v[132:135], v[112:127]
    ds_read_b128 v[128:131], v52 offset:38944
    ds_read_b128 v[132:135], v52 offset:43552
    ds_read_b64_tr_b16 v[136:137], v53 offset:44032
    ds_read_b64_tr_b16 v[138:139], v53 offset:45312
    ds_read_b64_tr_b16 v[140:141], v53 offset:44096
    ds_read_b64_tr_b16 v[142:143], v53 offset:45376
    s_waitcnt lgkmcnt(0)
    v_mfma_f32_32x32x16_bf16 v[64:79], v[136:139], v[128:131], v[64:79]
    v_mfma_f32_32x32x16_bf16 v[80:95], v[136:139], v[132:135], v[80:95]
    v_mfma_f32_32x32x16_bf16 v[96:111], v[140:143], v[128:131], v[96:111]
    v_mfma_f32_32x32x16_bf16 v[112:127], v[140:143], v[132:135], v[112:127]
    ds_read_b128 v[128:131], v52 offset:38976
    ds_read_b128 v[132:135], v52 offset:43584
    ds_read_b64_tr_b16 v[136:137], v53 offset:49152
    ds_read_b64_tr_b16 v[138:139], v53 offset:50432
    ds_read_b64_tr_b16 v[140:141], v53 offset:49216
    ds_read_b64_tr_b16 v[142:143], v53 offset:50496
    s_waitcnt lgkmcnt(0)
    v_mfma_f32_32x32x16_bf16 v[64:79], v[136:139], v[128:131], v[64:79]
    v_mfma_f32_32x32x16_bf16 v[80:95], v[136:139], v[132:135], v[80:95]
    v_mfma_f32_32x32x16_bf16 v[96:111], v[140:143], v[128:131], v[96:111]
    v_mfma_f32_32x32x16_bf16 v[112:127], v[140:143], v[132:135], v[112:127]
    ds_read_b128 v[128:131], v52 offset:39008
    ds_read_b128 v[132:135], v52 offset:43616
    ds_read_b64_tr_b16 v[136:137], v53 offset:54272
    ds_read_b64_tr_b16 v[138:139], v53 offset:55552
    ds_read_b64_tr_b16 v[140:141], v53 offset:54336
    ds_read_b64_tr_b16 v[142:143], v53 offset:55616
    s_waitcnt lgkmcnt(0)
    v_mfma_f32_32x32x16_bf16 v[64:79], v[136:139], v[128:131], v[64:79]
    v_mfma_f32_32x32x16_bf16 v[80:95], v[136:139], v[132:135], v[80:95]
    v_mfma_f32_32x32x16_bf16 v[96:111], v[140:143], v[128:131], v[96:111]
    v_mfma_f32_32x32x16_bf16 v[112:127], v[140:143], v[132:135], v[112:127]
    s_waitcnt vmcnt(0)
    ds_write_b128 v10, v[16:19] offset:0
    ds_write_b128 v10, v[20:23] offset:4608
    ds_write_b128 v10, v[24:27] offset:9216
    ds_write_b128 v10, v[28:31] offset:13824
    ds_write_b128 v11, v[32:35] offset:0
    ds_write_b128 v11, v[36:39] offset:5120
    ds_write_b128 v11, v[40:43] offset:10240
    ds_write_b128 v11, v[44:47] offset:15360
    s_waitcnt lgkmcnt(0)
    s_barrier
    ds_read_b128 v[128:131], v52 offset:0
    ds_read_b128 v[132:135], v52 offset:4608
    ds_read_b64_tr_b16 v[136:137], v53 offset:0
    ds_read_b64_tr_b16 v[138:139], v53 offset:1280
    ds_read_b64_tr_b16 v[140:141], v53 offset:64
    ds_read_b64_tr_b16 v[142:143], v53 offset:1344
    s_waitcnt lgkmcnt(0)
    v_mfma_f32_32x32x16_bf16 v[64:79], v[136:139], v[128:131], v[64:79]
    v_mfma_f32_32x32x16_bf16 v[80:95], v[136:139], v[132:135], v[80:95]
    v_mfma_f32_32x32x16_bf16 v[96:111], v[140:143], v[128:131], v[96:111]
    v_mfma_f32_32x32x16_bf16 v[112:127], v[140:143], v[132:135], v[112:127]
    ds_read_b128 v[128:131], v52 offset:32
    ds_read_b128 v[132:135], v52 offset:4640
    ds_read_b64_tr_b16 v[136:137], v53 offset:5120
    ds_read_b64_tr_b16 v[138:139], v53 offset:6400
    ds_read_b64_tr_b16 v[140:141], v53 offset:5184
    ds_read_b64_tr_b16 v[142:143], v53 offset:6464
    s_waitcnt lgkmcnt(0)
    v_mfma_f32_32x32x16_bf16 v[64:79], v[136:139], v[128:131], v[64:79]
    v_mfma_f32_32x32x16_bf16 v[80:95], v[136:139], v[132:135], v[80:95]
    v_mfma_f32_32x32x16_bf16 v[96:111], v[140:143], v[128:131], v[96:111]
    v_mfma_f32_32x32x16_bf16 v[112:127], v[140:143], v[132:135], v[112:127]
    ds_read_b128 v[128:131], v52 offset:64
    ds_read_b128 v[132:135], v52 offset:4672
    ds_read_b64_tr_b16 v[136:137], v53 offset:10240
    ds_read_b64_tr_b16 v[138:139], v53 offset:11520
    ds_read_b64_tr_b16 v[140:141], v53 offset:10304
    ds_read_b64_tr_b16 v[142:143], v53 offset:11584
    s_waitcnt lgkmcnt(0)
    v_mfma_f32_32x32x16_bf16 v[64:79], v[136:139], v[128:131], v[64:79]
    v_mfma_f32_32x32x16_bf16 v[80:95], v[136:139], v[132:135], v[80:95]
    v_mfma_f32_32x32x16_bf16 v[96:111], v[140:143], v[128:131], v[96:111]
    v_mfma_f32_32x32x16_bf16 v[112:127], v[140:143], v[132:135], v[112:127]
    ds_read_b128 v[128:131], v52 offset:96
    ds_read_b128 v[132:135], v52 offset:4704
    ds_read_b64_tr_b16 v[136:137], v53 offset:15360
    ds_read_b64_tr_b16 v[138:139], v53 offset:16640
    ds_read_b64_tr_b16 v[140:141], v53 offset:15424
    ds_read_b64_tr_b16 v[142:143], v53 offset:16704
    s_waitcnt lgkmcnt(0)
    v_mfma_f32_32x32x16_bf16 v[64:79], v[136:139], v[128:131], v[64:79]
    v_mfma_f32_32x32x16_bf16 v[80:95], v[136:139], v[132:135], v[80:95]
    v_mfma_f32_32x32x16_bf16 v[96:111], v[140:143], v[128:131], v[96:111]
    v_mfma_f32_32x32x16_bf16 v[112:127], v[140:143], v[132:135], v[112:127]
    s_nop 15
    v_and_b32 v2, 31, v1
    s_lshl_b32 s35, s36, 6
    s_add_u32 s35, s35, s39
    v_add_u32 v2, s35, v2
    v_lshrrev_b32 v3, 5, v1
    v_lshlrev_b32 v3, 2, v3
    s_mul_i32 s35, s37, 64
    v_add_u32 v3, s35, v3
    s_lshl_b32 s35, s3, 7
    v_add_u32 v3, s35, v3
    v_add_u32 v4, 0, v3
    v_add_u32 v13, 0, v2
    v_mul_u32_u24 v14, 2688, v13
    v_lshl_add_u32 v14, v4, 1, v14
    v_add_u32 v14, 3145728, v14
    v_cvt_pk_bf16_f32 v8, v64, v65
    v_cvt_pk_bf16_f32 v9, v66, v67
    v_cmp_gt_u32 vcc, 1344, v4
    s_and_saveexec_b64 s[48:49], vcc
    buffer_store_dwordx2 v[8:9], v14, s[44:47], 0 offen
    s_mov_b64 exec, s[48:49]
    s_nop 1
    v_add_u32 v13, 32, v2
    v_mul_u32_u24 v14, 2688, v13
    v_lshl_add_u32 v14, v4, 1, v14
    v_add_u32 v14, 3145728, v14
    v_cvt_pk_bf16_f32 v8, v80, v81
    v_cvt_pk_bf16_f32 v9, v82, v83
    v_cmp_gt_u32 vcc, 1344, v4
    s_and_saveexec_b64 s[48:49], vcc
    buffer_store_dwordx2 v[8:9], v14, s[44:47], 0 offen
    s_mov_b64 exec, s[48:49]
    s_nop 1
    v_add_u32 v4, 8, v3
    v_add_u32 v13, 0, v2
    v_mul_u32_u24 v14, 2688, v13
    v_lshl_add_u32 v14, v4, 1, v14
    v_add_u32 v14, 3145728, v14
    v_cvt_pk_bf16_f32 v8, v68, v69
    v_cvt_pk_bf16_f32 v9, v70, v71
    v_cmp_gt_u32 vcc, 1344, v4
    s_and_saveexec_b64 s[48:49], vcc
    buffer_store_dwordx2 v[8:9], v14, s[44:47], 0 offen
    s_mov_b64 exec, s[48:49]
    s_nop 1
    v_add_u32 v13, 32, v2
    v_mul_u32_u24 v14, 2688, v13
    v_lshl_add_u32 v14, v4, 1, v14
    v_add_u32 v14, 3145728, v14
    v_cvt_pk_bf16_f32 v8, v84, v85
    v_cvt_pk_bf16_f32 v9, v86, v87
    v_cmp_gt_u32 vcc, 1344, v4
    s_and_saveexec_b64 s[48:49], vcc
    buffer_store_dwordx2 v[8:9], v14, s[44:47], 0 offen
    s_mov_b64 exec, s[48:49]
    s_nop 1
    v_add_u32 v4, 16, v3
    v_add_u32 v13, 0, v2
    v_mul_u32_u24 v14, 2688, v13
    v_lshl_add_u32 v14, v4, 1, v14
    v_add_u32 v14, 3145728, v14
    v_cvt_pk_bf16_f32 v8, v72, v73
    v_cvt_pk_bf16_f32 v9, v74, v75
    v_cmp_gt_u32 vcc, 1344, v4
    s_and_saveexec_b64 s[48:49], vcc
    buffer_store_dwordx2 v[8:9], v14, s[44:47], 0 offen
    s_mov_b64 exec, s[48:49]
    s_nop 1
    v_add_u32 v13, 32, v2
    v_mul_u32_u24 v14, 2688, v13
    v_lshl_add_u32 v14, v4, 1, v14
    v_add_u32 v14, 3145728, v14
    v_cvt_pk_bf16_f32 v8, v88, v89
    v_cvt_pk_bf16_f32 v9, v90, v91
    v_cmp_gt_u32 vcc, 1344, v4
    s_and_saveexec_b64 s[48:49], vcc
    buffer_store_dwordx2 v[8:9], v14, s[44:47], 0 offen
    s_mov_b64 exec, s[48:49]
    s_nop 1
    v_add_u32 v4, 24, v3
    v_add_u32 v13, 0, v2
    v_mul_u32_u24 v14, 2688, v13
    v_lshl_add_u32 v14, v4, 1, v14
    v_add_u32 v14, 3145728, v14
    v_cvt_pk_bf16_f32 v8, v76, v77
    v_cvt_pk_bf16_f32 v9, v78, v79
    v_cmp_gt_u32 vcc, 1344, v4
    s_and_saveexec_b64 s[48:49], vcc
    buffer_store_dwordx2 v[8:9], v14, s[44:47], 0 offen
    s_mov_b64 exec, s[48:49]
    s_nop 1
    v_add_u32 v13, 32, v2
    v_mul_u32_u24 v14, 2688, v13
    v_lshl_add_u32 v14, v4, 1, v14
    v_add_u32 v14, 3145728, v14
    v_cvt_pk_bf16_f32 v8, v92, v93
    v_cvt_pk_bf16_f32 v9, v94, v95
    v_cmp_gt_u32 vcc, 1344, v4
    s_and_saveexec_b64 s[48:49], vcc
    buffer_store_dwordx2 v[8:9], v14, s[44:47], 0 offen
    s_mov_b64 exec, s[48:49]
    s_nop 1
    v_add_u32 v4, 32, v3
    v_add_u32 v13, 0, v2
    v_mul_u32_u24 v14, 2688, v13
    v_lshl_add_u32 v14, v4, 1, v14
    v_add_u32 v14, 3145728, v14
    v_cvt_pk_bf16_f32 v8, v96, v97
    v_cvt_pk_bf16_f32 v9, v98, v99
    v_cmp_gt_u32 vcc, 1344, v4
    s_and_saveexec_b64 s[48:49], vcc
    buffer_store_dwordx2 v[8:9], v14, s[44:47], 0 offen
    s_mov_b64 exec, s[48:49]
    s_nop 1
    v_add_u32 v13, 32, v2
    v_mul_u32_u24 v14, 2688, v13
    v_lshl_add_u32 v14, v4, 1, v14
    v_add_u32 v14, 3145728, v14
    v_cvt_pk_bf16_f32 v8, v112, v113
    v_cvt_pk_bf16_f32 v9, v114, v115
    v_cmp_gt_u32 vcc, 1344, v4
    s_and_saveexec_b64 s[48:49], vcc
    buffer_store_dwordx2 v[8:9], v14, s[44:47], 0 offen
    s_mov_b64 exec, s[48:49]
    s_nop 1
    v_add_u32 v4, 40, v3
    v_add_u32 v13, 0, v2
    v_mul_u32_u24 v14, 2688, v13
    v_lshl_add_u32 v14, v4, 1, v14
    v_add_u32 v14, 3145728, v14
    v_cvt_pk_bf16_f32 v8, v100, v101
    v_cvt_pk_bf16_f32 v9, v102, v103
    v_cmp_gt_u32 vcc, 1344, v4
    s_and_saveexec_b64 s[48:49], vcc
    buffer_store_dwordx2 v[8:9], v14, s[44:47], 0 offen
    s_mov_b64 exec, s[48:49]
    s_nop 1
    v_add_u32 v13, 32, v2
    v_mul_u32_u24 v14, 2688, v13
    v_lshl_add_u32 v14, v4, 1, v14
    v_add_u32 v14, 3145728, v14
    v_cvt_pk_bf16_f32 v8, v116, v117
    v_cvt_pk_bf16_f32 v9, v118, v119
    v_cmp_gt_u32 vcc, 1344, v4
    s_and_saveexec_b64 s[48:49], vcc
    buffer_store_dwordx2 v[8:9], v14, s[44:47], 0 offen
    s_mov_b64 exec, s[48:49]
    s_nop 1
    v_add_u32 v4, 48, v3
    v_add_u32 v13, 0, v2
    v_mul_u32_u24 v14, 2688, v13
    v_lshl_add_u32 v14, v4, 1, v14
    v_add_u32 v14, 3145728, v14
    v_cvt_pk_bf16_f32 v8, v104, v105
    v_cvt_pk_bf16_f32 v9, v106, v107
    v_cmp_gt_u32 vcc, 1344, v4
    s_and_saveexec_b64 s[48:49], vcc
    buffer_store_dwordx2 v[8:9], v14, s[44:47], 0 offen
    s_mov_b64 exec, s[48:49]
    s_nop 1
    v_add_u32 v13, 32, v2
    v_mul_u32_u24 v14, 2688, v13
    v_lshl_add_u32 v14, v4, 1, v14
    v_add_u32 v14, 3145728, v14
    v_cvt_pk_bf16_f32 v8, v120, v121
    v_cvt_pk_bf16_f32 v9, v122, v123
    v_cmp_gt_u32 vcc, 1344, v4
    s_and_saveexec_b64 s[48:49], vcc
    buffer_store_dwordx2 v[8:9], v14, s[44:47], 0 offen
    s_mov_b64 exec, s[48:49]
    s_nop 1
    v_add_u32 v4, 56, v3
    v_add_u32 v13, 0, v2
    v_mul_u32_u24 v14, 2688, v13
    v_lshl_add_u32 v14, v4, 1, v14
    v_add_u32 v14, 3145728, v14
    v_cvt_pk_bf16_f32 v8, v108, v109
    v_cvt_pk_bf16_f32 v9, v110, v111
    v_cmp_gt_u32 vcc, 1344, v4
    s_and_saveexec_b64 s[48:49], vcc
    buffer_store_dwordx2 v[8:9], v14, s[44:47], 0 offen
    s_mov_b64 exec, s[48:49]
    s_nop 1
    v_add_u32 v13, 32, v2
    v_mul_u32_u24 v14, 2688, v13
    v_lshl_add_u32 v14, v4, 1, v14
    v_add_u32 v14, 3145728, v14
    v_cvt_pk_bf16_f32 v8, v124, v125
    v_cvt_pk_bf16_f32 v9, v126, v127
    v_cmp_gt_u32 vcc, 1344, v4
    s_and_saveexec_b64 s[48:49], vcc
    buffer_store_dwordx2 v[8:9], v14, s[44:47], 0 offen
    s_mov_b64 exec, s[48:49]
    s_nop 1
K1_END:
    s_endpgm
.p2align 8
.globl k2_kernel
.type k2_kernel,@function
k2_kernel:
    s_cmp_ge_u32 s2, 320
    s_cbranch_scc1 K2_END
    s_load_dwordx2 s[16:17], s[0:1], 80
    s_waitcnt lgkmcnt(0)
    s_mov_b32 s44, s16
    s_and_b32 s45, s17, 0xffff
    s_mov_b32 s46, 268435456
    s_mov_b32 s47, 0x20000
    s_cmp_ge_u32 s2, 256
    s_cbranch_scc1 K2_B
    v_and_b32 v1, 63, v0
    v_lshrrev_b32 v2, 6, v0
    s_nop 0
    v_readfirstlane_b32 s3, v2
    s_and_b32 s4, s3, 3
    s_lshr_b32 s5, s3, 2
    s_lshl_b32 s6, s2, 2
    s_add_u32 s6, s6, s4
    s_lshl_b32 s6, s6, 11
    v_lshlrev_b32 v2, 4, v1
    buffer_load_dwordx4 v[8:11], v2, s[44:47], s6 offen
    buffer_load_dwordx4 v[12:15], v2, s[44:47], s6 offen offset:1024
    s_lshl_b32 s7, s5, 5
    s_add_u32 s7, s7, s4
    s_lshl_b32 s7, s7, 12
    s_add_u32 s7, s7, 2097152
    s_lshl_b32 s8, s3, 12
    s_lshl_b32 s9, s5, 14
    v_add_u32 v3, s9, v2
    v_mov_b32 v32, 0
    v_mov_b32 v64, 0
    v_mov_b32 v33, 0
    v_mov_b32 v65, 0
    v_mov_b32 v34, 0
    v_mov_b32 v66, 0
    v_mov_b32 v35, 0
    v_mov_b32 v67, 0
    v_mov_b32 v36, 0
    v_mov_b32 v68, 0
    v_mov_b32 v37, 0
    v_mov_b32 v69, 0
    v_mov_b32 v38, 0
    v_mov_b32 v70, 0
    v_mov_b32 v39, 0
    v_mov_b32 v71, 0
    v_mov_b32 v40, 0
    v_mov_b32 v72, 0
    v_mov_b32 v41, 0
    v_mov_b32 v73, 0
    v_mov_b32 v42, 0
    v_mov_b32 v74, 0
    v_mov_b32 v43, 0
    v_mov_b32 v75, 0
    v_mov_b32 v44, 0
    v_mov_b32 v76, 0
    v_mov_b32 v45, 0
    v_mov_b32 v77, 0
    v_mov_b32 v46, 0
    v_mov_b32 v78, 0
    v_mov_b32 v47, 0
    v_mov_b32 v79, 0
    v_mov_b32 v4, 0
    s_mov_b32 s10, 0xff800000
    s_mov_b32 s11, 0xff800000
    s_lshr_b32 s13, s2, 3
    s_and_b32 s13, s13, 7
    s_mov_b32 m0, s8
    s_nop 0
    s_lshl_b32 s14, s13, 14
    s_add_u32 s14, s14, s7
    buffer_load_dwordx4 v2, s[44:47], s14 offen offset:0 lds
    buffer_load_dwordx4 v2, s[44:47], s14 offen offset:1024 lds
    buffer_load_dwordx4 v2, s[44:47], s14 offen offset:2048 lds
    buffer_load_dwordx4 v2, s[44:47], s14 offen offset:3072 lds
    s_add_u32 s13, s13, 1
    s_and_b32 s13, s13, 7
    s_xor_b32 s8, s8, 32768
    s_mov_b32 s12, 0
K2_LOOP:
    s_waitcnt vmcnt(0)
    s_barrier
    s_cmp_eq_u32 s12, 7
    s_cbranch_scc1 K2_NODMA
    s_mov_b32 m0, s8
    s_nop 0
    s_lshl_b32 s14, s13, 14
    s_add_u32 s14, s14, s7
    buffer_load_dwordx4 v2, s[44:47], s14 offen offset:0 lds
    buffer_load_dwordx4 v2, s[44:47], s14 offen offset:1024 lds
    buffer_load_dwordx4 v2, s[44:47], s14 offen offset:2048 lds
    buffer_load_dwordx4 v2, s[44:47], s14 offen offset:3072 lds
    s_add_u32 s13, s13, 1
    s_and_b32 s13, s13, 7
    s_xor_b32 s8, s8, 32768
K2_NODMA:
    ds_read_b128 v[16:19], v3 offset:0
    ds_read_b128 v[20:23], v3 offset:1024
    ds_read_b128 v[24:27], v3 offset:2048
    ds_read_b128 v[28:31], v3 offset:3072
    s_waitcnt lgkmcnt(0)
    v_mfma_f32_32x32x16_bf16 v[48:63], v[16:19], v[8:11], v[32:47]
    v_mfma_f32_32x32x16_bf16 v[48:63], v[20:23], v[12:15], v[48:63]
    s_nop 7
    ds_read_b128 v[96:99], v3 offset:4096
    ds_read_b128 v[100:103], v3 offset:5120
    ds_read_b128 v[104:107], v3 offset:6144
    ds_read_b128 v[108:111], v3 offset:7168
    s_nop 7
    v_max3_f32 v5, v48, v49, v50
    v_max3_f32 v5, v5, v51, v52
    v_max3_f32 v5, v5, v53, v54
    v_max3_f32 v5, v5, v55, v56
    v_max3_f32 v5, v5, v57, v58
    v_max3_f32 v5, v5, v59, v60
    v_max3_f32 v5, v5, v61, v62
    v_max_f32 v5, v5, v63
    v_cmp_lt_f32 vcc, s10, v5
    s_cbranch_vccnz K2_SLOW0
K2_BACK0:
    v_exp_f32 v48, v48
    v_exp_f32 v49, v49
    v_exp_f32 v50, v50
    v_exp_f32 v51, v51
    v_exp_f32 v52, v52
    v_exp_f32 v53, v53
    v_exp_f32 v54, v54
    v_exp_f32 v55, v55
    v_exp_f32 v56, v56
    v_exp_f32 v57, v57
    v_exp_f32 v58, v58
    v_exp_f32 v59, v59
    v_exp_f32 v60, v60
    v_exp_f32 v61, v61
    v_exp_f32 v62, v62
    v_exp_f32 v63, v63
    s_nop 0
    v_cvt_pk_bf16_f32 v48, v48, v49
    v_cvt_pk_bf16_f32 v49, v50, v51
    v_cvt_pk_bf16_f32 v50, v52, v53
    v_cvt_pk_bf16_f32 v51, v54, v55
    v_cvt_pk_bf16_f32 v52, v56, v57
    v_cvt_pk_bf16_f32 v53, v58, v59
    v_cvt_pk_bf16_f32 v54, v60, v61
    v_cvt_pk_bf16_f32 v55, v62, v63
    s_waitcnt lgkmcnt(0)
    s_nop 1
    v_mfma_f32_32x32x16_bf16 v[80:95], v[96:99], v[8:11], v[32:47]
    v_mfma_f32_32x32x16_bf16 v[80:95], v[100:103], v[12:15], v[80:95]
    v_mfma_f32_32x32x16_bf16 v[64:79], v[24:27], v[48:51], v[64:79]
    v_mfma_f32_32x32x16_bf16 v[64:79], v[28:31], v[52:55], v[64:79]
    ds_read_b128 v[16:19], v3 offset:8192
    ds_read_b128 v[20:23], v3 offset:9216
    ds_read_b128 v[24:27], v3 offset:10240
    ds_read_b128 v[28:31], v3 offset:11264
    s_nop 7
    v_max3_f32 v5, v80, v81, v82
    v_max3_f32 v5, v5, v83, v84
    v_max3_f32 v5, v5, v85, v86
    v_max3_f32 v5, v5, v87, v88
    v_max3_f32 v5, v5, v89, v90
    v_max3_f32 v5, v5, v91, v92
    v_max3_f32 v5, v5, v93, v94
    v_max_f32 v5, v5, v95
    v_cmp_lt_f32 vcc, s10, v5
    s_cbranch_vccnz K2_SLOW1
K2_BACK1:
    v_exp_f32 v80, v80
    v_exp_f32 v81, v81
    v_exp_f32 v82, v82
    v_exp_f32 v83, v83
    v_exp_f32 v84, v84
    v_exp_f32 v85, v85
    v_exp_f32 v86, v86
    v_exp_f32 v87, v87
    v_exp_f32 v88, v88
    v_exp_f32 v89, v89
    v_exp_f32 v90, v90
    v_exp_f32 v91, v91
    v_exp_f32 v92, v92
    v_exp_f32 v93, v93
    v_exp_f32 v94, v94
    v_exp_f32 v95, v95
    s_nop 0
    v_cvt_pk_bf16_f32 v80, v80, v81
    v_cvt_pk_bf16_f32 v81, v82, v83
    v_cvt_pk_bf16_f32 v82, v84, v85
    v_cvt_pk_bf16_f32 v83, v86, v87
    v_cvt_pk_bf16_f32 v84, v88, v89
    v_cvt_pk_bf16_f32 v85, v90, v91
    v_cvt_pk_bf16_f32 v86, v92, v93
    v_cvt_pk_bf16_f32 v87, v94, v95
    s_waitcnt lgkmcnt(0)
    s_nop 1
    v_mfma_f32_32x32x16_bf16 v[48:63], v[16:19], v[8:11], v[32:47]
    v_mfma_f32_32x32x16_bf16 v[48:63], v[20:23], v[12:15], v[48:63]
    v_mfma_f32_32x32x16_bf16 v[64:79], v[104:107], v[80:83], v[64:79]
    v_mfma_f32_32x32x16_bf16 v[64:79], v[108:111], v[84:87], v[64:79]
    ds_read_b128 v[96:99], v3 offset:12288
    ds_read_b128 v[100:103], v3 offset:13312
    ds_read_b128 v[104:107], v3 offset:14336
    ds_read_b128 v[108:111], v3 offset:15360
    s_nop 7
    v_max3_f32 v5, v48, v49, v50
    v_max3_f32 v5, v5, v51, v52
    v_max3_f32 v5, v5, v53, v54
    v_max3_f32 v5, v5, v55, v56
    v_max3_f32 v5, v5, v57, v58
    v_max3_f32 v5, v5, v59, v60
    v_max3_f32 v5, v5, v61, v62
    v_max_f32 v5, v5, v63
    v_cmp_lt_f32 vcc, s10, v5
    s_cbranch_vccnz K2_SLOW2
K2_BACK2:
    v_exp_f32 v48, v48
    v_exp_f32 v49, v49
    v_exp_f32 v50, v50
    v_exp_f32 v51, v51
    v_exp_f32 v52, v52
    v_exp_f32 v53, v53
    v_exp_f32 v54, v54
    v_exp_f32 v55, v55
    v_exp_f32 v56, v56
    v_exp_f32 v57, v57
    v_exp_f32 v58, v58
    v_exp_f32 v59, v59
    v_exp_f32 v60, v60
    v_exp_f32 v61, v61
    v_exp_f32 v62, v62
    v_exp_f32 v63, v63
    s_nop 0
    v_cvt_pk_bf16_f32 v48, v48, v49
    v_cvt_pk_bf16_f32 v49, v50, v51
    v_cvt_pk_bf16_f32 v50, v52, v53
    v_cvt_pk_bf16_f32 v51, v54, v55
    v_cvt_pk_bf16_f32 v52, v56, v57
    v_cvt_pk_bf16_f32 v53, v58, v59
    v_cvt_pk_bf16_f32 v54, v60, v61
    v_cvt_pk_bf16_f32 v55, v62, v63
    s_waitcnt lgkmcnt(0)
    s_nop 1
    v_mfma_f32_32x32x16_bf16 v[80:95], v[96:99], v[8:11], v[32:47]
    v_mfma_f32_32x32x16_bf16 v[80:95], v[100:103], v[12:15], v[80:95]
    v_mfma_f32_32x32x16_bf16 v[64:79], v[24:27], v[48:51], v[64:79]
    v_mfma_f32_32x32x16_bf16 v[64:79], v[28:31], v[52:55], v[64:79]
    s_nop 7
    v_max3_f32 v5, v80, v81, v82
    v_max3_f32 v5, v5, v83, v84
    v_max3_f32 v5, v5, v85, v86
    v_max3_f32 v5, v5, v87, v88
    v_max3_f32 v5, v5, v89, v90
    v_max3_f32 v5, v5, v91, v92
    v_max3_f32 v5, v5, v93, v94
    v_max_f32 v5, v5, v95
    v_cmp_lt_f32 vcc, s10, v5
    s_cbranch_vccnz K2_SLOW3
K2_BACK3:
    v_exp_f32 v80, v80
    v_exp_f32 v81, v81
    v_exp_f32 v82, v82
    v_exp_f32 v83, v83
    v_exp_f32 v84, v84
    v_exp_f32 v85, v85
    v_exp_f32 v86, v86
    v_exp_f32 v87, v87
    v_exp_f32 v88, v88
    v_exp_f32 v89, v89
    v_exp_f32 v90, v90
    v_exp_f32 v91, v91
    v_exp_f32 v92, v92
    v_exp_f32 v93, v93
    v_exp_f32 v94, v94
    v_exp_f32 v95, v95
    s_nop 0
    v_cvt_pk_bf16_f32 v80, v80, v81
    v_cvt_pk_bf16_f32 v81, v82, v83
    v_cvt_pk_bf16_f32 v82, v84, v85
    v_cvt_pk_bf16_f32 v83, v86, v87
    v_cvt_pk_bf16_f32 v84, v88, v89
    v_cvt_pk_bf16_f32 v85, v90, v91
    v_cvt_pk_bf16_f32 v86, v92, v93
    v_cvt_pk_bf16_f32 v87, v94, v95
    s_waitcnt lgkmcnt(0)
    s_nop 1
    v_mfma_f32_32x32x16_bf16 v[64:79], v[104:107], v[80:83], v[64:79]
    v_mfma_f32_32x32x16_bf16 v[64:79], v[108:111], v[84:87], v[64:79]
    v_xor_b32 v3, 0x8000, v3
    s_add_u32 s12, s12, 1
    s_cmp_lt_u32 s12, 8
    s_cbranch_scc1 K2_LOOP
    s_branch K2_FIN
K2_SLOW0:
    s_nop 7
    v_mov_b32 v6, v5
    s_nop 1
    v_permlane32_swap_b32 v5, v6
    s_nop 1
    v_max_f32 v5, v5, v6
    v_max_f32 v5, s11, v5
    v_add_f32 v4, v4, v5
    v_sub_f32 v6, 0, v5
    v_min_f32 v6, 0x42c80000, v6
    v_exp_f32 v6, v6
    v_sub_f32 v32, v32, v5
    v_sub_f32 v48, v48, v5
    v_sub_f32 v33, v33, v5
    v_sub_f32 v49, v49, v5
    v_sub_f32 v34, v34, v5
    v_sub_f32 v50, v50, v5
    v_sub_f32 v35, v35, v5
    v_sub_f32 v51, v51, v5
    v_sub_f32 v36, v36, v5
    v_sub_f32 v52, v52, v5
    v_sub_f32 v37, v37, v5
    v_sub_f32 v53, v53, v5
    v_sub_f32 v38, v38, v5
    v_sub_f32 v54, v54, v5
    v_sub_f32 v39, v39, v5
    v_sub_f32 v55, v55, v5
    v_sub_f32 v40, v40, v5
    v_sub_f32 v56, v56, v5
    v_sub_f32 v41, v41, v5
    v_sub_f32 v57, v57, v5
    v_sub_f32 v42, v42, v5
    v_sub_f32 v58, v58, v5
    v_sub_f32 v43, v43, v5
    v_sub_f32 v59, v59, v5
    v_sub_f32 v44, v44, v5
    v_sub_f32 v60, v60, v5
    v_sub_f32 v45, v45, v5
    v_sub_f32 v61, v61, v5
    v_sub_f32 v46, v46, v5
    v_sub_f32 v62, v62, v5
    v_sub_f32 v47, v47, v5
    v_sub_f32 v63, v63, v5
    v_mul_f32 v64, v64, v6
    v_mul_f32 v65, v65, v6
    v_mul_f32 v66, v66, v6
    v_mul_f32 v67, v67, v6
    v_mul_f32 v68, v68, v6
    v_mul_f32 v69, v69, v6
    v_mul_f32 v70, v70, v6
    v_mul_f32 v71, v71, v6
    v_mul_f32 v72, v72, v6
    v_mul_f32 v73, v73, v6
    v_mul_f32 v74, v74, v6
    v_mul_f32 v75, v75, v6
    v_mul_f32 v76, v76, v6
    v_mul_f32 v77, v77, v6
    v_mul_f32 v78, v78, v6
    v_mul_f32 v79, v79, v6
    s_mov_b32 s10, 0x41000000
    s_mov_b32 s11, 0
    s_branch K2_BACK0
K2_SLOW1:
    s_nop 7
    v_mov_b32 v6, v5
    s_nop 1
    v_permlane32_swap_b32 v5, v6
    s_nop 1
    v_max_f32 v5, v5, v6
    v_max_f32 v5, s11, v5
    v_add_f32 v4, v4, v5
    v_sub_f32 v6, 0, v5
    v_min_f32 v6, 0x42c80000, v6
    v_exp_f32 v6, v6
    v_sub_f32 v32, v32, v5
    v_sub_f32 v80, v80, v5
    v_sub_f32 v33, v33, v5
    v_sub_f32 v81, v81, v5
    v_sub_f32 v34, v34, v5
    v_sub_f32 v82, v82, v5
    v_sub_f32 v35, v35, v5
    v_sub_f32 v83, v83, v5
    v_sub_f32 v36, v36, v5
    v_sub_f32 v84, v84, v5
    v_sub_f32 v37, v37, v5
    v_sub_f32 v85, v85, v5
    v_sub_f32 v38, v38, v5
    v_sub_f32 v86, v86, v5
    v_sub_f32 v39, v39, v5
    v_sub_f32 v87, v87, v5
    v_sub_f32 v40, v40, v5
    v_sub_f32 v88, v88, v5
    v_sub_f32 v41, v41, v5
    v_sub_f32 v89, v89, v5
    v_sub_f32 v42, v42, v5
    v_sub_f32 v90, v90, v5
    v_sub_f32 v43, v43, v5
    v_sub_f32 v91, v91, v5
    v_sub_f32 v44, v44, v5
    v_sub_f32 v92, v92, v5
    v_sub_f32 v45, v45, v5
    v_sub_f32 v93, v93, v5
    v_sub_f32 v46, v46, v5
    v_sub_f32 v94, v94, v5
    v_sub_f32 v47, v47, v5
    v_sub_f32 v95, v95, v5
    v_mul_f32 v64, v64, v6
    v_mul_f32 v65, v65, v6
    v_mul_f32 v66, v66, v6
    v_mul_f32 v67, v67, v6
    v_mul_f32 v68, v68, v6
    v_mul_f32 v69, v69, v6
    v_mul_f32 v70, v70, v6
    v_mul_f32 v71, v71, v6
    v_mul_f32 v72, v72, v6
    v_mul_f32 v73, v73, v6
    v_mul_f32 v74, v74, v6
    v_mul_f32 v75, v75, v6
    v_mul_f32 v76, v76, v6
    v_mul_f32 v77, v77, v6
    v_mul_f32 v78, v78, v6
    v_mul_f32 v79, v79, v6
    s_mov_b32 s10, 0x41000000
    s_mov_b32 s11, 0
    s_branch K2_BACK1
K2_SLOW2:
    s_nop 7
    v_mov_b32 v6, v5
    s_nop 1
    v_permlane32_swap_b32 v5, v6
    s_nop 1
    v_max_f32 v5, v5, v6
    v_max_f32 v5, s11, v5
    v_add_f32 v4, v4, v5
    v_sub_f32 v6, 0, v5
    v_min_f32 v6, 0x42c80000, v6
    v_exp_f32 v6, v6
    v_sub_f32 v32, v32, v5
    v_sub_f32 v48, v48, v5
    v_sub_f32 v33, v33, v5
    v_sub_f32 v49, v49, v5
    v_sub_f32 v34, v34, v5
    v_sub_f32 v50, v50, v5
    v_sub_f32 v35, v35, v5
    v_sub_f32 v51, v51, v5
    v_sub_f32 v36, v36, v5
    v_sub_f32 v52, v52, v5
    v_sub_f32 v37, v37, v5
    v_sub_f32 v53, v53, v5
    v_sub_f32 v38, v38, v5
    v_sub_f32 v54, v54, v5
    v_sub_f32 v39, v39, v5
    v_sub_f32 v55, v55, v5
    v_sub_f32 v40, v40, v5
    v_sub_f32 v56, v56, v5
    v_sub_f32 v41, v41, v5
    v_sub_f32 v57, v57, v5
    v_sub_f32 v42, v42, v5
    v_sub_f32 v58, v58, v5
    v_sub_f32 v43, v43, v5
    v_sub_f32 v59, v59, v5
    v_sub_f32 v44, v44, v5
    v_sub_f32 v60, v60, v5
    v_sub_f32 v45, v45, v5
    v_sub_f32 v61, v61, v5
    v_sub_f32 v46, v46, v5
    v_sub_f32 v62, v62, v5
    v_sub_f32 v47, v47, v5
    v_sub_f32 v63, v63, v5
    v_mul_f32 v64, v64, v6
    v_mul_f32 v65, v65, v6
    v_mul_f32 v66, v66, v6
    v_mul_f32 v67, v67, v6
    v_mul_f32 v68, v68, v6
    v_mul_f32 v69, v69, v6
    v_mul_f32 v70, v70, v6
    v_mul_f32 v71, v71, v6
    v_mul_f32 v72, v72, v6
    v_mul_f32 v73, v73, v6
    v_mul_f32 v74, v74, v6
    v_mul_f32 v75, v75, v6
    v_mul_f32 v76, v76, v6
    v_mul_f32 v77, v77, v6
    v_mul_f32 v78, v78, v6
    v_mul_f32 v79, v79, v6
    s_mov_b32 s10, 0x41000000
    s_mov_b32 s11, 0
    s_branch K2_BACK2
K2_SLOW3:
    s_nop 7
    v_mov_b32 v6, v5
    s_nop 1
    v_permlane32_swap_b32 v5, v6
    s_nop 1
    v_max_f32 v5, v5, v6
    v_max_f32 v5, s11, v5
    v_add_f32 v4, v4, v5
    v_sub_f32 v6, 0, v5
    v_min_f32 v6, 0x42c80000, v6
    v_exp_f32 v6, v6
    v_sub_f32 v32, v32, v5
    v_sub_f32 v80, v80, v5
    v_sub_f32 v33, v33, v5
    v_sub_f32 v81, v81, v5
    v_sub_f32 v34, v34, v5
    v_sub_f32 v82, v82, v5
    v_sub_f32 v35, v35, v5
    v_sub_f32 v83, v83, v5
    v_sub_f32 v36, v36, v5
    v_sub_f32 v84, v84, v5
    v_sub_f32 v37, v37, v5
    v_sub_f32 v85, v85, v5
    v_sub_f32 v38, v38, v5
    v_sub_f32 v86, v86, v5
    v_sub_f32 v39, v39, v5
    v_sub_f32 v87, v87, v5
    v_sub_f32 v40, v40, v5
    v_sub_f32 v88, v88, v5
    v_sub_f32 v41, v41, v5
    v_sub_f32 v89, v89, v5
    v_sub_f32 v42, v42, v5
    v_sub_f32 v90, v90, v5
    v_sub_f32 v43, v43, v5
    v_sub_f32 v91, v91, v5
    v_sub_f32 v44, v44, v5
    v_sub_f32 v92, v92, v5
    v_sub_f32 v45, v45, v5
    v_sub_f32 v93, v93, v5
    v_sub_f32 v46, v46, v5
    v_sub_f32 v94, v94, v5
    v_sub_f32 v47, v47, v5
    v_sub_f32 v95, v95, v5
    v_mul_f32 v64, v64, v6
    v_mul_f32 v65, v65, v6
    v_mul_f32 v66, v66, v6
    v_mul_f32 v67, v67, v6
    v_mul_f32 v68, v68, v6
    v_mul_f32 v69, v69, v6
    v_mul_f32 v70, v70, v6
    v_mul_f32 v71, v71, v6
    v_mul_f32 v72, v72, v6
    v_mul_f32 v73, v73, v6
    v_mul_f32 v74, v74, v6
    v_mul_f32 v75, v75, v6
    v_mul_f32 v76, v76, v6
    v_mul_f32 v77, v77, v6
    v_mul_f32 v78, v78, v6
    v_mul_f32 v79, v79, v6
    s_mov_b32 s10, 0x41000000
    s_mov_b32 s11, 0
    s_branch K2_BACK3
K2_FIN:
    s_nop 15
    s_barrier
    s_lshl_b32 s9, s4, 13
    v_lshlrev_b32 v3, 2, v1
    v_add_u32 v3, s9, v3
    s_cmp_eq_u32 s5, 0
    s_cbranch_scc1 K2_H0
    ds_write_b32 v3, v64 offset:0
    ds_write_b32 v3, v65 offset:256
    ds_write_b32 v3, v66 offset:512
    ds_write_b32 v3, v67 offset:768
    ds_write_b32 v3, v68 offset:1024
    ds_write_b32 v3, v69 offset:1280
    ds_write_b32 v3, v70 offset:1536
    ds_write_b32 v3, v71 offset:1792
    ds_write_b32 v3, v72 offset:2048
    ds_write_b32 v3, v73 offset:2304
    ds_write_b32 v3, v74 offset:2560
    ds_write_b32 v3, v75 offset:2816
    ds_write_b32 v3, v76 offset:3072
    ds_write_b32 v3, v77 offset:3328
    ds_write_b32 v3, v78 offset:3584
    ds_write_b32 v3, v79 offset:3840
    ds_write_b32 v3, v4 offset:4096
    s_waitcnt lgkmcnt(0)
    s_barrier
    s_endpgm
K2_H0:
    s_barrier
    ds_read_b32 v32, v3 offset:0
    ds_read_b32 v33, v3 offset:256
    ds_read_b32 v34, v3 offset:512
    ds_read_b32 v35, v3 offset:768
    ds_read_b32 v36, v3 offset:1024
    ds_read_b32 v37, v3 offset:1280
    ds_read_b32 v38, v3 offset:1536
    ds_read_b32 v39, v3 offset:1792
    ds_read_b32 v40, v3 offset:2048
    ds_read_b32 v41, v3 offset:2304
    ds_read_b32 v42, v3 offset:2560
    ds_read_b32 v43, v3 offset:2816
    ds_read_b32 v44, v3 offset:3072
    ds_read_b32 v45, v3 offset:3328
    ds_read_b32 v46, v3 offset:3584
    ds_read_b32 v47, v3 offset:3840
    ds_read_b32 v5, v3 offset:4096
    s_waitcnt lgkmcnt(0)
    v_max_f32 v6, v4, v5
    v_sub_f32 v4, v4, v6
    v_sub_f32 v5, v5, v6
    v_exp_f32 v4, v4
    v_exp_f32 v5, v5
    s_nop 0
    v_mul_f32 v64, v64, v4
    v_fmac_f32 v64, v32, v5
    v_mul_f32 v65, v65, v4
    v_fmac_f32 v65, v33, v5
    v_mul_f32 v66, v66, v4
    v_fmac_f32 v66, v34, v5
    v_mul_f32 v67, v67, v4
    v_fmac_f32 v67, v35, v5
    v_mul_f32 v68, v68, v4
    v_fmac_f32 v68, v36, v5
    v_mul_f32 v69, v69, v4
    v_fmac_f32 v69, v37, v5
    v_mul_f32 v70, v70, v4
    v_fmac_f32 v70, v38, v5
    v_mul_f32 v71, v71, v4
    v_fmac_f32 v71, v39, v5
    v_mul_f32 v72, v72, v4
    v_fmac_f32 v72, v40, v5
    v_mul_f32 v73, v73, v4
    v_fmac_f32 v73, v41, v5
    v_mul_f32 v74, v74, v4
    v_fmac_f32 v74, v42, v5
    v_mul_f32 v75, v75, v4
    v_fmac_f32 v75, v43, v5
    v_mul_f32 v76, v76, v4
    v_fmac_f32 v76, v44, v5
    v_mul_f32 v77, v77, v4
    v_fmac_f32 v77, v45, v5
    v_mul_f32 v78, v78, v4
    v_fmac_f32 v78, v46, v5
    v_mul_f32 v79, v79, v4
    v_fmac_f32 v79, v47, v5
    v_mov_b32 v5, v76
    v_mov_b32 v6, v76
    s_nop 1
    v_permlane32_swap_b32 v5, v6
    s_nop 1
    v_rcp_f32 v6, v6
    s_nop 0
    v_mul_f32 v64, v64, v6
    v_mul_f32 v65, v65, v6
    v_mul_f32 v66, v66, v6
    v_mul_f32 v67, v67, v6
    v_mul_f32 v68, v68, v6
    v_mul_f32 v69, v69, v6
    v_mul_f32 v70, v70, v6
    v_mul_f32 v71, v71, v6
    v_mul_f32 v72, v72, v6
    v_mul_f32 v73, v73, v6
    v_mul_f32 v74, v74, v6
    v_mul_f32 v75, v75, v6
    v_mul_f32 v76, v76, v6
    v_mul_f32 v77, v77, v6
    v_mul_f32 v78, v78, v6
    v_mul_f32 v79, v79, v6
    v_and_b32 v5, 7, v1
    s_lshl_b32 s9, s2, 3
    v_add_u32 v5, s9, v5
    v_mul_u32_u24 v5, 896, v5
    v_bfe_u32 v6, v1, 3, 2
    s_lshl_b32 s9, s4, 2
    v_add_u32 v6, s9, v6
    v_mul_u32_u24 v6, 56, v6
    v_add_u32 v5, v5, v6
    v_lshrrev_b32 v6, 5, v1
    v_lshl_add_u32 v5, v6, 3, v5
    v_add_u32 v5, 9437184, v5
    v_cvt_pk_bf16_f32 v32, v64, v65
    v_cvt_pk_bf16_f32 v33, v66, v67
    buffer_store_dwordx2 v[32:33], v5, s[44:47], 0 offen offset:0
    v_cvt_pk_bf16_f32 v34, v68, v69
    v_cvt_pk_bf16_f32 v35, v70, v71
    buffer_store_dwordx2 v[34:35], v5, s[44:47], 0 offen offset:16
    v_cvt_pk_bf16_f32 v36, v72, v73
    v_cvt_pk_bf16_f32 v37, v74, v75
    buffer_store_dwordx2 v[36:37], v5, s[44:47], 0 offen offset:32
    v_cvt_pk_bf16_f32 v38, v76, v77
    v_cvt_pk_bf16_f32 v39, v78, v79
    v_cmp_gt_u32 vcc, 32, v1
    s_and_saveexec_b64 s[48:49], vcc
    buffer_store_dwordx2 v[38:39], v5, s[44:47], 0 offen offset:48
    s_endpgm
K2_B:
    s_sub_u32 s3, s2, 256
    s_lshl_b32 s3, s3, 9
    v_add_u32 v1, s3, v0
    v_lshrrev_b32 v2, 4, v1
    v_and_b32 v3, 15, v1
    v_mul_u32_u24 v3, 56, v3
    v_mul_u32_u24 v4, 2688, v2
    v_add_u32 v4, v4, v3
    v_add_u32 v4, 3145728, v4
    buffer_load_dwordx4 v[16:19], v4, s[44:47], 0 offen offset:0
    buffer_load_dwordx4 v[20:23], v4, s[44:47], 0 offen offset:16
    buffer_load_dwordx4 v[24:27], v4, s[44:47], 0 offen offset:32
    buffer_load_dwordx2 v[28:29], v4, s[44:47], 0 offen offset:48
    v_subrev_u32 v5, 0, v2
    v_max_i32 v5, 0, v5
    v_mul_u32_u24 v8, 2688, v5
    v_add_u32 v8, v8, v3
    v_add_u32 v8, 3145728, v8
    v_subrev_u32 v5, 2, v2
    v_max_i32 v5, 0, v5
    v_mul_u32_u24 v9, 2688, v5
    v_add_u32 v9, v9, v3
    v_add_u32 v9, 3145728, v9
    v_subrev_u32 v5, 4, v2
    v_max_i32 v5, 0, v5
    v_mul_u32_u24 v10, 2688, v5
    v_add_u32 v10, v10, v3
    v_add_u32 v10, 3145728, v10
    v_subrev_u32 v5, 6, v2
    v_max_i32 v5, 0, v5
    v_mul_u32_u24 v11, 2688, v5
    v_add_u32 v11, v11, v3
    v_add_u32 v11, 3145728, v11
    v_subrev_u32 v5, 8, v2
    v_max_i32 v5, 0, v5
    v_mul_u32_u24 v12, 2688, v5
    v_add_u32 v12, v12, v3
    v_add_u32 v12, 3145728, v12
    v_subrev_u32 v5, 10, v2
    v_max_i32 v5, 0, v5
    v_mul_u32_u24 v13, 2688, v5
    v_add_u32 v13, v13, v3
    v_add_u32 v13, 3145728, v13
    v_subrev_u32 v5, 12, v2
    v_max_i32 v5, 0, v5
    v_mul_u32_u24 v14, 2688, v5
    v_add_u32 v14, v14, v3
    v_add_u32 v14, 3145728, v14
    v_subrev_u32 v5, 14, v2
    v_max_i32 v5, 0, v5
    v_mul_u32_u24 v15, 2688, v5
    v_add_u32 v15, v15, v3
    v_add_u32 v15, 3145728, v15
    buffer_load_dwordx4 v[100:103], v8, s[44:47], 0 offen offset:896
    buffer_load_dwordx4 v[104:107], v8, s[44:47], 0 offen offset:912
    buffer_load_dwordx4 v[108:111], v8, s[44:47], 0 offen offset:928
    buffer_load_dwordx2 v[112:113], v8, s[44:47], 0 offen offset:944
    buffer_load_dwordx4 v[116:119], v9, s[44:47], 0 offen offset:896
    buffer_load_dwordx4 v[120:123], v9, s[44:47], 0 offen offset:912
    buffer_load_dwordx4 v[124:127], v9, s[44:47], 0 offen offset:928
    buffer_load_dwordx2 v[128:129], v9, s[44:47], 0 offen offset:944
    buffer_load_dwordx4 v[132:135], v10, s[44:47], 0 offen offset:896
    buffer_load_dwordx4 v[136:139], v10, s[44:47], 0 offen offset:912
    buffer_load_dwordx4 v[140:143], v10, s[44:47], 0 offen offset:928
    buffer_load_dwordx2 v[144:145], v10, s[44:47], 0 offen offset:944
    buffer_load_dwordx4 v[148:151], v11, s[44:47], 0 offen offset:896
    buffer_load_dwordx4 v[152:155], v11, s[44:47], 0 offen offset:912
    buffer_load_dwordx4 v[156:159], v11, s[44:47], 0 offen offset:928
    buffer_load_dwordx2 v[160:161], v11, s[44:47], 0 offen offset:944
    s_waitcnt vmcnt(16)
    v_and_b32 v33, 0xffff0000, v16
    v_lshlrev_b32 v32, 16, v16
    v_and_b32 v35, 0xffff0000, v17
    v_lshlrev_b32 v34, 16, v17
    v_and_b32 v37, 0xffff0000, v18
    v_lshlrev_b32 v36, 16, v18
    v_and_b32 v39, 0xffff0000, v19
    v_lshlrev_b32 v38, 16, v19
    v_and_b32 v41, 0xffff0000, v20
    v_lshlrev_b32 v40, 16, v20
    v_and_b32 v43, 0xffff0000, v21
    v_lshlrev_b32 v42, 16, v21
    v_and_b32 v45, 0xffff0000, v22
    v_lshlrev_b32 v44, 16, v22
    v_and_b32 v47, 0xffff0000, v23
    v_lshlrev_b32 v46, 16, v23
    v_and_b32 v49, 0xffff0000, v24
    v_lshlrev_b32 v48, 16, v24
    v_and_b32 v51, 0xffff0000, v25
    v_lshlrev_b32 v50, 16, v25
    v_and_b32 v53, 0xffff0000, v26
    v_lshlrev_b32 v52, 16, v26
    v_and_b32 v55, 0xffff0000, v27
    v_lshlrev_b32 v54, 16, v27
    v_and_b32 v57, 0xffff0000, v28
    v_lshlrev_b32 v56, 16, v28
    v_and_b32 v59, 0xffff0000, v29
    v_lshlrev_b32 v58, 16, v29
    s_waitcnt vmcnt(12)
    v_and_b32 v61, 0xffff0000, v100
    v_lshlrev_b32 v60, 16, v100
    v_and_b32 v63, 0xffff0000, v101
    v_lshlrev_b32 v62, 16, v101
    v_and_b32 v65, 0xffff0000, v102
    v_lshlrev_b32 v64, 16, v102
    v_and_b32 v67, 0xffff0000, v103
    v_lshlrev_b32 v66, 16, v103
    v_and_b32 v69, 0xffff0000, v104
    v_lshlrev_b32 v68, 16, v104
    v_and_b32 v71, 0xffff0000, v105
    v_lshlrev_b32 v70, 16, v105
    v_and_b32 v73, 0xffff0000, v106
    v_lshlrev_b32 v72, 16, v106
    v_and_b32 v75, 0xffff0000, v107
    v_lshlrev_b32 v74, 16, v107
    v_and_b32 v77, 0xffff0000, v108
    v_lshlrev_b32 v76, 16, v108
    v_and_b32 v79, 0xffff0000, v109
    v_lshlrev_b32 v78, 16, v109
    v_and_b32 v81, 0xffff0000, v110
    v_lshlrev_b32 v80, 16, v110
    v_and_b32 v83, 0xffff0000, v111
    v_lshlrev_b32 v82, 16, v111
    v_and_b32 v85, 0xffff0000, v112
    v_lshlrev_b32 v84, 16, v112
    v_and_b32 v87, 0xffff0000, v113
    v_lshlrev_b32 v86, 16, v113
    buffer_load_dwordx4 v[100:103], v12, s[44:47], 0 offen offset:896
    buffer_load_dwordx4 v[104:107], v12, s[44:47], 0 offen offset:912
    buffer_load_dwordx4 v[108:111], v12, s[44:47], 0 offen offset:928
    buffer_load_dwordx2 v[112:113], v12, s[44:47], 0 offen offset:944
    v_mul_f32 v88, v32, v60
    v_fmac_f32 v88, v33, v61
    v_fmac_f32 v88, v34, v62
    v_fmac_f32 v88, v35, v63
    v_fmac_f32 v88, v36, v64
    v_fmac_f32 v88, v37, v65
    v_fmac_f32 v88, v38, v66
    v_fmac_f32 v88, v39, v67
    v_fmac_f32 v88, v40, v68
    v_fmac_f32 v88, v41, v69
    v_fmac_f32 v88, v42, v70
    v_fmac_f32 v88, v43, v71
    v_fmac_f32 v88, v44, v72
    v_fmac_f32 v88, v45, v73
    v_fmac_f32 v88, v46, v74
    v_fmac_f32 v88, v47, v75
    v_fmac_f32 v88, v48, v76
    v_fmac_f32 v88, v49, v77
    v_fmac_f32 v88, v50, v78
    v_fmac_f32 v88, v51, v79
    v_fmac_f32 v88, v52, v80
    v_fmac_f32 v88, v53, v81
    v_fmac_f32 v88, v54, v82
    v_fmac_f32 v88, v55, v83
    v_fmac_f32 v88, v56, v84
    v_fmac_f32 v88, v57, v85
    v_fmac_f32 v88, v58, v86
    v_fmac_f32 v88, v59, v87
    v_cmp_gt_u32 vcc, 0, v2
    v_mov_b32 v6, 0xce6e6b28
    v_mul_f32 v88, 0x3e8b97f6, v88
    v_cndmask_b32 v88, v88, v6, vcc
    s_waitcnt vmcnt(12)
    v_and_b32 v61, 0xffff0000, v116
    v_lshlrev_b32 v60, 16, v116
    v_and_b32 v63, 0xffff0000, v117
    v_lshlrev_b32 v62, 16, v117
    v_and_b32 v65, 0xffff0000, v118
    v_lshlrev_b32 v64, 16, v118
    v_and_b32 v67, 0xffff0000, v119
    v_lshlrev_b32 v66, 16, v119
    v_and_b32 v69, 0xffff0000, v120
    v_lshlrev_b32 v68, 16, v120
    v_and_b32 v71, 0xffff0000, v121
    v_lshlrev_b32 v70, 16, v121
    v_and_b32 v73, 0xffff0000, v122
    v_lshlrev_b32 v72, 16, v122
    v_and_b32 v75, 0xffff0000, v123
    v_lshlrev_b32 v74, 16, v123
    v_and_b32 v77, 0xffff0000, v124
    v_lshlrev_b32 v76, 16, v124
    v_and_b32 v79, 0xffff0000, v125
    v_lshlrev_b32 v78, 16, v125
    v_and_b32 v81, 0xffff0000, v126
    v_lshlrev_b32 v80, 16, v126
    v_and_b32 v83, 0xffff0000, v127
    v_lshlrev_b32 v82, 16, v127
    v_and_b32 v85, 0xffff0000, v128
    v_lshlrev_b32 v84, 16, v128
    v_and_b32 v87, 0xffff0000, v129
    v_lshlrev_b32 v86, 16, v129
    buffer_load_dwordx4 v[116:119], v13, s[44:47], 0 offen offset:896
    buffer_load_dwordx4 v[120:123], v13, s[44:47], 0 offen offset:912
    buffer_load_dwordx4 v[124:127], v13, s[44:47], 0 offen offset:928
    buffer_load_dwordx2 v[128:129], v13, s[44:47], 0 offen offset:944
    v_mul_f32 v89, v32, v60
    v_fmac_f32 v89, v33, v61
    v_fmac_f32 v89, v34, v62
    v_fmac_f32 v89, v35, v63
    v_fmac_f32 v89, v36, v64
    v_fmac_f32 v89, v37, v65
    v_fmac_f32 v89, v38, v66
    v_fmac_f32 v89, v39, v67
    v_fmac_f32 v89, v40, v68
    v_fmac_f32 v89, v41, v69
    v_fmac_f32 v89, v42, v70
    v_fmac_f32 v89, v43, v71
    v_fmac_f32 v89, v44, v72
    v_fmac_f32 v89, v45, v73
    v_fmac_f32 v89, v46, v74
    v_fmac_f32 v89, v47, v75
    v_fmac_f32 v89, v48, v76
    v_fmac_f32 v89, v49, v77
    v_fmac_f32 v89, v50, v78
    v_fmac_f32 v89, v51, v79
    v_fmac_f32 v89, v52, v80
    v_fmac_f32 v89, v53, v81
    v_fmac_f32 v89, v54, v82
    v_fmac_f32 v89, v55, v83
    v_fmac_f32 v89, v56, v84
    v_fmac_f32 v89, v57, v85
    v_fmac_f32 v89, v58, v86
    v_fmac_f32 v89, v59, v87
    v_cmp_gt_u32 vcc, 2, v2
    v_mov_b32 v6, 0xce6e6b28
    v_mul_f32 v89, 0x3e8b97f6, v89
    v_cndmask_b32 v89, v89, v6, vcc
    s_waitcnt vmcnt(12)
    v_and_b32 v61, 0xffff0000, v132
    v_lshlrev_b32 v60, 16, v132
    v_and_b32 v63, 0xffff0000, v133
    v_lshlrev_b32 v62, 16, v133
    v_and_b32 v65, 0xffff0000, v134
    v_lshlrev_b32 v64, 16, v134
    v_and_b32 v67, 0xffff0000, v135
    v_lshlrev_b32 v66, 16, v135
    v_and_b32 v69, 0xffff0000, v136
    v_lshlrev_b32 v68, 16, v136
    v_and_b32 v71, 0xffff0000, v137
    v_lshlrev_b32 v70, 16, v137
    v_and_b32 v73, 0xffff0000, v138
    v_lshlrev_b32 v72, 16, v138
    v_and_b32 v75, 0xffff0000, v139
    v_lshlrev_b32 v74, 16, v139
    v_and_b32 v77, 0xffff0000, v140
    v_lshlrev_b32 v76, 16, v140
    v_and_b32 v79, 0xffff0000, v141
    v_lshlrev_b32 v78, 16, v141
    v_and_b32 v81, 0xffff0000, v142
    v_lshlrev_b32 v80, 16, v142
    v_and_b32 v83, 0xffff0000, v143
    v_lshlrev_b32 v82, 16, v143
    v_and_b32 v85, 0xffff0000, v144
    v_lshlrev_b32 v84, 16, v144
    v_and_b32 v87, 0xffff0000, v145
    v_lshlrev_b32 v86, 16, v145
    buffer_load_dwordx4 v[132:135], v14, s[44:47], 0 offen offset:896
    buffer_load_dwordx4 v[136:139], v14, s[44:47], 0 offen offset:912
    buffer_load_dwordx4 v[140:143], v14, s[44:47], 0 offen offset:928
    buffer_load_dwordx2 v[144:145], v14, s[44:47], 0 offen offset:944
    v_mul_f32 v90, v32, v60
    v_fmac_f32 v90, v33, v61
    v_fmac_f32 v90, v34, v62
    v_fmac_f32 v90, v35, v63
    v_fmac_f32 v90, v36, v64
    v_fmac_f32 v90, v37, v65
    v_fmac_f32 v90, v38, v66
    v_fmac_f32 v90, v39, v67
    v_fmac_f32 v90, v40, v68
    v_fmac_f32 v90, v41, v69
    v_fmac_f32 v90, v42, v70
    v_fmac_f32 v90, v43, v71
    v_fmac_f32 v90, v44, v72
    v_fmac_f32 v90, v45, v73
    v_fmac_f32 v90, v46, v74
    v_fmac_f32 v90, v47, v75
    v_fmac_f32 v90, v48, v76
    v_fmac_f32 v90, v49, v77
    v_fmac_f32 v90, v50, v78
    v_fmac_f32 v90, v51, v79
    v_fmac_f32 v90, v52, v80
    v_fmac_f32 v90, v53, v81
    v_fmac_f32 v90, v54, v82
    v_fmac_f32 v90, v55, v83
    v_fmac_f32 v90, v56, v84
    v_fmac_f32 v90, v57, v85
    v_fmac_f32 v90, v58, v86
    v_fmac_f32 v90, v59, v87
    v_cmp_gt_u32 vcc, 4, v2
    v_mov_b32 v6, 0xce6e6b28
    v_mul_f32 v90, 0x3e8b97f6, v90
    v_cndmask_b32 v90, v90, v6, vcc
    s_waitcnt vmcnt(12)
    v_and_b32 v61, 0xffff0000, v148
    v_lshlrev_b32 v60, 16, v148
    v_and_b32 v63, 0xffff0000, v149
    v_lshlrev_b32 v62, 16, v149
    v_and_b32 v65, 0xffff0000, v150
    v_lshlrev_b32 v64, 16, v150
    v_and_b32 v67, 0xffff0000, v151
    v_lshlrev_b32 v66, 16, v151
    v_and_b32 v69, 0xffff0000, v152
    v_lshlrev_b32 v68, 16, v152
    v_and_b32 v71, 0xffff0000, v153
    v_lshlrev_b32 v70, 16, v153
    v_and_b32 v73, 0xffff0000, v154
    v_lshlrev_b32 v72, 16, v154
    v_and_b32 v75, 0xffff0000, v155
    v_lshlrev_b32 v74, 16, v155
    v_and_b32 v77, 0xffff0000, v156
    v_lshlrev_b32 v76, 16, v156
    v_and_b32 v79, 0xffff0000, v157
    v_lshlrev_b32 v78, 16, v157
    v_and_b32 v81, 0xffff0000, v158
    v_lshlrev_b32 v80, 16, v158
    v_and_b32 v83, 0xffff0000, v159
    v_lshlrev_b32 v82, 16, v159
    v_and_b32 v85, 0xffff0000, v160
    v_lshlrev_b32 v84, 16, v160
    v_and_b32 v87, 0xffff0000, v161
    v_lshlrev_b32 v86, 16, v161
    buffer_load_dwordx4 v[148:151], v15, s[44:47], 0 offen offset:896
    buffer_load_dwordx4 v[152:155], v15, s[44:47], 0 offen offset:912
    buffer_load_dwordx4 v[156:159], v15, s[44:47], 0 offen offset:928
    buffer_load_dwordx2 v[160:161], v15, s[44:47], 0 offen offset:944
    v_mul_f32 v91, v32, v60
    v_fmac_f32 v91, v33, v61
    v_fmac_f32 v91, v34, v62
    v_fmac_f32 v91, v35, v63
    v_fmac_f32 v91, v36, v64
    v_fmac_f32 v91, v37, v65
    v_fmac_f32 v91, v38, v66
    v_fmac_f32 v91, v39, v67
    v_fmac_f32 v91, v40, v68
    v_fmac_f32 v91, v41, v69
    v_fmac_f32 v91, v42, v70
    v_fmac_f32 v91, v43, v71
    v_fmac_f32 v91, v44, v72
    v_fmac_f32 v91, v45, v73
    v_fmac_f32 v91, v46, v74
    v_fmac_f32 v91, v47, v75
    v_fmac_f32 v91, v48, v76
    v_fmac_f32 v91, v49, v77
    v_fmac_f32 v91, v50, v78
    v_fmac_f32 v91, v51, v79
    v_fmac_f32 v91, v52, v80
    v_fmac_f32 v91, v53, v81
    v_fmac_f32 v91, v54, v82
    v_fmac_f32 v91, v55, v83
    v_fmac_f32 v91, v56, v84
    v_fmac_f32 v91, v57, v85
    v_fmac_f32 v91, v58, v86
    v_fmac_f32 v91, v59, v87
    v_cmp_gt_u32 vcc, 6, v2
    v_mov_b32 v6, 0xce6e6b28
    v_mul_f32 v91, 0x3e8b97f6, v91
    v_cndmask_b32 v91, v91, v6, vcc
    s_waitcnt vmcnt(12)
    v_and_b32 v61, 0xffff0000, v100
    v_lshlrev_b32 v60, 16, v100
    v_and_b32 v63, 0xffff0000, v101
    v_lshlrev_b32 v62, 16, v101
    v_and_b32 v65, 0xffff0000, v102
    v_lshlrev_b32 v64, 16, v102
    v_and_b32 v67, 0xffff0000, v103
    v_lshlrev_b32 v66, 16, v103
    v_and_b32 v69, 0xffff0000, v104
    v_lshlrev_b32 v68, 16, v104
    v_and_b32 v71, 0xffff0000, v105
    v_lshlrev_b32 v70, 16, v105
    v_and_b32 v73, 0xffff0000, v106
    v_lshlrev_b32 v72, 16, v106
    v_and_b32 v75, 0xffff0000, v107
    v_lshlrev_b32 v74, 16, v107
    v_and_b32 v77, 0xffff0000, v108
    v_lshlrev_b32 v76, 16, v108
    v_and_b32 v79, 0xffff0000, v109
    v_lshlrev_b32 v78, 16, v109
    v_and_b32 v81, 0xffff0000, v110
    v_lshlrev_b32 v80, 16, v110
    v_and_b32 v83, 0xffff0000, v111
    v_lshlrev_b32 v82, 16, v111
    v_and_b32 v85, 0xffff0000, v112
    v_lshlrev_b32 v84, 16, v112
    v_and_b32 v87, 0xffff0000, v113
    v_lshlrev_b32 v86, 16, v113
    v_mul_f32 v92, v32, v60
    v_fmac_f32 v92, v33, v61
    v_fmac_f32 v92, v34, v62
    v_fmac_f32 v92, v35, v63
    v_fmac_f32 v92, v36, v64
    v_fmac_f32 v92, v37, v65
    v_fmac_f32 v92, v38, v66
    v_fmac_f32 v92, v39, v67
    v_fmac_f32 v92, v40, v68
    v_fmac_f32 v92, v41, v69
    v_fmac_f32 v92, v42, v70
    v_fmac_f32 v92, v43, v71
    v_fmac_f32 v92, v44, v72
    v_fmac_f32 v92, v45, v73
    v_fmac_f32 v92, v46, v74
    v_fmac_f32 v92, v47, v75
    v_fmac_f32 v92, v48, v76
    v_fmac_f32 v92, v49, v77
    v_fmac_f32 v92, v50, v78
    v_fmac_f32 v92, v51, v79
    v_fmac_f32 v92, v52, v80
    v_fmac_f32 v92, v53, v81
    v_fmac_f32 v92, v54, v82
    v_fmac_f32 v92, v55, v83
    v_fmac_f32 v92, v56, v84
    v_fmac_f32 v92, v57, v85
    v_fmac_f32 v92, v58, v86
    v_fmac_f32 v92, v59, v87
    v_cmp_gt_u32 vcc, 8, v2
    v_mov_b32 v6, 0xce6e6b28
    v_mul_f32 v92, 0x3e8b97f6, v92
    v_cndmask_b32 v92, v92, v6, vcc
    s_waitcnt vmcnt(8)
    v_and_b32 v61, 0xffff0000, v116
    v_lshlrev_b32 v60, 16, v116
    v_and_b32 v63, 0xffff0000, v117
    v_lshlrev_b32 v62, 16, v117
    v_and_b32 v65, 0xffff0000, v118
    v_lshlrev_b32 v64, 16, v118
    v_and_b32 v67, 0xffff0000, v119
    v_lshlrev_b32 v66, 16, v119
    v_and_b32 v69, 0xffff0000, v120
    v_lshlrev_b32 v68, 16, v120
    v_and_b32 v71, 0xffff0000, v121
    v_lshlrev_b32 v70, 16, v121
    v_and_b32 v73, 0xffff0000, v122
    v_lshlrev_b32 v72, 16, v122
    v_and_b32 v75, 0xffff0000, v123
    v_lshlrev_b32 v74, 16, v123
    v_and_b32 v77, 0xffff0000, v124
    v_lshlrev_b32 v76, 16, v124
    v_and_b32 v79, 0xffff0000, v125
    v_lshlrev_b32 v78, 16, v125
    v_and_b32 v81, 0xffff0000, v126
    v_lshlrev_b32 v80, 16, v126
    v_and_b32 v83, 0xffff0000, v127
    v_lshlrev_b32 v82, 16, v127
    v_and_b32 v85, 0xffff0000, v128
    v_lshlrev_b32 v84, 16, v128
    v_and_b32 v87, 0xffff0000, v129
    v_lshlrev_b32 v86, 16, v129
    v_mul_f32 v93, v32, v60
    v_fmac_f32 v93, v33, v61
    v_fmac_f32 v93, v34, v62
    v_fmac_f32 v93, v35, v63
    v_fmac_f32 v93, v36, v64
    v_fmac_f32 v93, v37, v65
    v_fmac_f32 v93, v38, v66
    v_fmac_f32 v93, v39, v67
    v_fmac_f32 v93, v40, v68
    v_fmac_f32 v93, v41, v69
    v_fmac_f32 v93, v42, v70
    v_fmac_f32 v93, v43, v71
    v_fmac_f32 v93, v44, v72
    v_fmac_f32 v93, v45, v73
    v_fmac_f32 v93, v46, v74
    v_fmac_f32 v93, v47, v75
    v_fmac_f32 v93, v48, v76
    v_fmac_f32 v93, v49, v77
    v_fmac_f32 v93, v50, v78
    v_fmac_f32 v93, v51, v79
    v_fmac_f32 v93, v52, v80
    v_fmac_f32 v93, v53, v81
    v_fmac_f32 v93, v54, v82
    v_fmac_f32 v93, v55, v83
    v_fmac_f32 v93, v56, v84
    v_fmac_f32 v93, v57, v85
    v_fmac_f32 v93, v58, v86
    v_fmac_f32 v93, v59, v87
    v_cmp_gt_u32 vcc, 10, v2
    v_mov_b32 v6, 0xce6e6b28
    v_mul_f32 v93, 0x3e8b97f6, v93
    v_cndmask_b32 v93, v93, v6, vcc
    s_waitcnt vmcnt(4)
    v_and_b32 v61, 0xffff0000, v132
    v_lshlrev_b32 v60, 16, v132
    v_and_b32 v63, 0xffff0000, v133
    v_lshlrev_b32 v62, 16, v133
    v_and_b32 v65, 0xffff0000, v134
    v_lshlrev_b32 v64, 16, v134
    v_and_b32 v67, 0xffff0000, v135
    v_lshlrev_b32 v66, 16, v135
    v_and_b32 v69, 0xffff0000, v136
    v_lshlrev_b32 v68, 16, v136
    v_and_b32 v71, 0xffff0000, v137
    v_lshlrev_b32 v70, 16, v137
    v_and_b32 v73, 0xffff0000, v138
    v_lshlrev_b32 v72, 16, v138
    v_and_b32 v75, 0xffff0000, v139
    v_lshlrev_b32 v74, 16, v139
    v_and_b32 v77, 0xffff0000, v140
    v_lshlrev_b32 v76, 16, v140
    v_and_b32 v79, 0xffff0000, v141
    v_lshlrev_b32 v78, 16, v141
    v_and_b32 v81, 0xffff0000, v142
    v_lshlrev_b32 v80, 16, v142
    v_and_b32 v83, 0xffff0000, v143
    v_lshlrev_b32 v82, 16, v143
    v_and_b32 v85, 0xffff0000, v144
    v_lshlrev_b32 v84, 16, v144
    v_and_b32 v87, 0xffff0000, v145
    v_lshlrev_b32 v86, 16, v145
    v_mul_f32 v94, v32, v60
    v_fmac_f32 v94, v33, v61
    v_fmac_f32 v94, v34, v62
    v_fmac_f32 v94, v35, v63
    v_fmac_f32 v94, v36, v64
    v_fmac_f32 v94, v37, v65
    v_fmac_f32 v94, v38, v66
    v_fmac_f32 v94, v39, v67
    v_fmac_f32 v94, v40, v68
    v_fmac_f32 v94, v41, v69
    v_fmac_f32 v94, v42, v70
    v_fmac_f32 v94, v43, v71
    v_fmac_f32 v94, v44, v72
    v_fmac_f32 v94, v45, v73
    v_fmac_f32 v94, v46, v74
    v_fmac_f32 v94, v47, v75
    v_fmac_f32 v94, v48, v76
    v_fmac_f32 v94, v49, v77
    v_fmac_f32 v94, v50, v78
    v_fmac_f32 v94, v51, v79
    v_fmac_f32 v94, v52, v80
    v_fmac_f32 v94, v53, v81
    v_fmac_f32 v94, v54, v82
    v_fmac_f32 v94, v55, v83
    v_fmac_f32 v94, v56, v84
    v_fmac_f32 v94, v57, v85
    v_fmac_f32 v94, v58, v86
    v_fmac_f32 v94, v59, v87
    v_cmp_gt_u32 vcc, 12, v2
    v_mov_b32 v6, 0xce6e6b28
    v_mul_f32 v94, 0x3e8b97f6, v94
    v_cndmask_b32 v94, v94, v6, vcc
    s_waitcnt vmcnt(0)
    v_and_b32 v61, 0xffff0000, v148
    v_lshlrev_b32 v60, 16, v148
    v_and_b32 v63, 0xffff0000, v149
    v_lshlrev_b32 v62, 16, v149
    v_and_b32 v65, 0xffff0000, v150
    v_lshlrev_b32 v64, 16, v150
    v_and_b32 v67, 0xffff0000, v151
    v_lshlrev_b32 v66, 16, v151
    v_and_b32 v69, 0xffff0000, v152
    v_lshlrev_b32 v68, 16, v152
    v_and_b32 v71, 0xffff0000, v153
    v_lshlrev_b32 v70, 16, v153
    v_and_b32 v73, 0xffff0000, v154
    v_lshlrev_b32 v72, 16, v154
    v_and_b32 v75, 0xffff0000, v155
    v_lshlrev_b32 v74, 16, v155
    v_and_b32 v77, 0xffff0000, v156
    v_lshlrev_b32 v76, 16, v156
    v_and_b32 v79, 0xffff0000, v157
    v_lshlrev_b32 v78, 16, v157
    v_and_b32 v81, 0xffff0000, v158
    v_lshlrev_b32 v80, 16, v158
    v_and_b32 v83, 0xffff0000, v159
    v_lshlrev_b32 v82, 16, v159
    v_and_b32 v85, 0xffff0000, v160
    v_lshlrev_b32 v84, 16, v160
    v_and_b32 v87, 0xffff0000, v161
    v_lshlrev_b32 v86, 16, v161
    v_mul_f32 v95, v32, v60
    v_fmac_f32 v95, v33, v61
    v_fmac_f32 v95, v34, v62
    v_fmac_f32 v95, v35, v63
    v_fmac_f32 v95, v36, v64
    v_fmac_f32 v95, v37, v65
    v_fmac_f32 v95, v38, v66
    v_fmac_f32 v95, v39, v67
    v_fmac_f32 v95, v40, v68
    v_fmac_f32 v95, v41, v69
    v_fmac_f32 v95, v42, v70
    v_fmac_f32 v95, v43, v71
    v_fmac_f32 v95, v44, v72
    v_fmac_f32 v95, v45, v73
    v_fmac_f32 v95, v46, v74
    v_fmac_f32 v95, v47, v75
    v_fmac_f32 v95, v48, v76
    v_fmac_f32 v95, v49, v77
    v_fmac_f32 v95, v50, v78
    v_fmac_f32 v95, v51, v79
    v_fmac_f32 v95, v52, v80
    v_fmac_f32 v95, v53, v81
    v_fmac_f32 v95, v54, v82
    v_fmac_f32 v95, v55, v83
    v_fmac_f32 v95, v56, v84
    v_fmac_f32 v95, v57, v85
    v_fmac_f32 v95, v58, v86
    v_fmac_f32 v95, v59, v87
    v_cmp_gt_u32 vcc, 14, v2
    v_mov_b32 v6, 0xce6e6b28
    v_mul_f32 v95, 0x3e8b97f6, v95
    v_cndmask_b32 v95, v95, v6, vcc
    buffer_load_dwordx4 v[100:103], v8, s[44:47], 0 offen offset:1792
    buffer_load_dwordx4 v[104:107], v8, s[44:47], 0 offen offset:1808
    buffer_load_dwordx4 v[108:111], v8, s[44:47], 0 offen offset:1824
    buffer_load_dwordx2 v[112:113], v8, s[44:47], 0 offen offset:1840
    buffer_load_dwordx4 v[116:119], v9, s[44:47], 0 offen offset:1792
    buffer_load_dwordx4 v[120:123], v9, s[44:47], 0 offen offset:1808
    buffer_load_dwordx4 v[124:127], v9, s[44:47], 0 offen offset:1824
    buffer_load_dwordx2 v[128:129], v9, s[44:47], 0 offen offset:1840
    buffer_load_dwordx4 v[132:135], v10, s[44:47], 0 offen offset:1792
    buffer_load_dwordx4 v[136:139], v10, s[44:47], 0 offen offset:1808
    buffer_load_dwordx4 v[140:143], v10, s[44:47], 0 offen offset:1824
    buffer_load_dwordx2 v[144:145], v10, s[44:47], 0 offen offset:1840
    buffer_load_dwordx4 v[148:151], v11, s[44:47], 0 offen offset:1792
    buffer_load_dwordx4 v[152:155], v11, s[44:47], 0 offen offset:1808
    buffer_load_dwordx4 v[156:159], v11, s[44:47], 0 offen offset:1824
    buffer_load_dwordx2 v[160:161], v11, s[44:47], 0 offen offset:1840
    v_max3_f32 v5, v88, v89, v90
    v_max3_f32 v5, v5, v91, v92
    v_max3_f32 v5, v5, v93, v94
    v_max_f32 v5, v5, v95
    v_sub_f32 v88, v88, v5
    v_exp_f32 v88, v88
    v_sub_f32 v89, v89, v5
    v_exp_f32 v89, v89
    v_sub_f32 v90, v90, v5
    v_exp_f32 v90, v90
    v_sub_f32 v91, v91, v5
    v_exp_f32 v91, v91
    v_sub_f32 v92, v92, v5
    v_exp_f32 v92, v92
    v_sub_f32 v93, v93, v5
    v_exp_f32 v93, v93
    v_sub_f32 v94, v94, v5
    v_exp_f32 v94, v94
    v_sub_f32 v95, v95, v5
    v_exp_f32 v95, v95
    s_nop 0
    v_add_f32 v5, v88, v89
    v_add_f32 v5, v5, v90
    v_add_f32 v5, v5, v91
    v_add_f32 v5, v5, v92
    v_add_f32 v5, v5, v93
    v_add_f32 v5, v5, v94
    v_add_f32 v5, v5, v95
    v_rcp_f32 v5, v5
    s_waitcnt vmcnt(12)
    v_and_b32 v61, 0xffff0000, v100
    v_lshlrev_b32 v60, 16, v100
    v_and_b32 v63, 0xffff0000, v101
    v_lshlrev_b32 v62, 16, v101
    v_and_b32 v65, 0xffff0000, v102
    v_lshlrev_b32 v64, 16, v102
    v_and_b32 v67, 0xffff0000, v103
    v_lshlrev_b32 v66, 16, v103
    v_and_b32 v69, 0xffff0000, v104
    v_lshlrev_b32 v68, 16, v104
    v_and_b32 v71, 0xffff0000, v105
    v_lshlrev_b32 v70, 16, v105
    v_and_b32 v73, 0xffff0000, v106
    v_lshlrev_b32 v72, 16, v106
    v_and_b32 v75, 0xffff0000, v107
    v_lshlrev_b32 v74, 16, v107
    v_and_b32 v77, 0xffff0000, v108
    v_lshlrev_b32 v76, 16, v108
    v_and_b32 v79, 0xffff0000, v109
    v_lshlrev_b32 v78, 16, v109
    v_and_b32 v81, 0xffff0000, v110
    v_lshlrev_b32 v80, 16, v110
    v_and_b32 v83, 0xffff0000, v111
    v_lshlrev_b32 v82, 16, v111
    v_and_b32 v85, 0xffff0000, v112
    v_lshlrev_b32 v84, 16, v112
    v_and_b32 v87, 0xffff0000, v113
    v_lshlrev_b32 v86, 16, v113
    buffer_load_dwordx4 v[100:103], v12, s[44:47], 0 offen offset:1792
    buffer_load_dwordx4 v[104:107], v12, s[44:47], 0 offen offset:1808
    buffer_load_dwordx4 v[108:111], v12, s[44:47], 0 offen offset:1824
    buffer_load_dwordx2 v[112:113], v12, s[44:47], 0 offen offset:1840
    v_mul_f32 v32, v88, v60
    v_mul_f32 v33, v88, v61
    v_mul_f32 v34, v88, v62
    v_mul_f32 v35, v88, v63
    v_mul_f32 v36, v88, v64
    v_mul_f32 v37, v88, v65
    v_mul_f32 v38, v88, v66
    v_mul_f32 v39, v88, v67
    v_mul_f32 v40, v88, v68
    v_mul_f32 v41, v88, v69
    v_mul_f32 v42, v88, v70
    v_mul_f32 v43, v88, v71
    v_mul_f32 v44, v88, v72
    v_mul_f32 v45, v88, v73
    v_mul_f32 v46, v88, v74
    v_mul_f32 v47, v88, v75
    v_mul_f32 v48, v88, v76
    v_mul_f32 v49, v88, v77
    v_mul_f32 v50, v88, v78
    v_mul_f32 v51, v88, v79
    v_mul_f32 v52, v88, v80
    v_mul_f32 v53, v88, v81
    v_mul_f32 v54, v88, v82
    v_mul_f32 v55, v88, v83
    v_mul_f32 v56, v88, v84
    v_mul_f32 v57, v88, v85
    v_mul_f32 v58, v88, v86
    v_mul_f32 v59, v88, v87
    s_waitcnt vmcnt(12)
    v_and_b32 v61, 0xffff0000, v116
    v_lshlrev_b32 v60, 16, v116
    v_and_b32 v63, 0xffff0000, v117
    v_lshlrev_b32 v62, 16, v117
    v_and_b32 v65, 0xffff0000, v118
    v_lshlrev_b32 v64, 16, v118
    v_and_b32 v67, 0xffff0000, v119
    v_lshlrev_b32 v66, 16, v119
    v_and_b32 v69, 0xffff0000, v120
    v_lshlrev_b32 v68, 16, v120
    v_and_b32 v71, 0xffff0000, v121
    v_lshlrev_b32 v70, 16, v121
    v_and_b32 v73, 0xffff0000, v122
    v_lshlrev_b32 v72, 16, v122
    v_and_b32 v75, 0xffff0000, v123
    v_lshlrev_b32 v74, 16, v123
    v_and_b32 v77, 0xffff0000, v124
    v_lshlrev_b32 v76, 16, v124
    v_and_b32 v79, 0xffff0000, v125
    v_lshlrev_b32 v78, 16, v125
    v_and_b32 v81, 0xffff0000, v126
    v_lshlrev_b32 v80, 16, v126
    v_and_b32 v83, 0xffff0000, v127
    v_lshlrev_b32 v82, 16, v127
    v_and_b32 v85, 0xffff0000, v128
    v_lshlrev_b32 v84, 16, v128
    v_and_b32 v87, 0xffff0000, v129
    v_lshlrev_b32 v86, 16, v129
    buffer_load_dwordx4 v[116:119], v13, s[44:47], 0 offen offset:1792
    buffer_load_dwordx4 v[120:123], v13, s[44:47], 0 offen offset:1808
    buffer_load_dwordx4 v[124:127], v13, s[44:47], 0 offen offset:1824
    buffer_load_dwordx2 v[128:129], v13, s[44:47], 0 offen offset:1840
    v_fmac_f32 v32, v89, v60
    v_fmac_f32 v33, v89, v61
    v_fmac_f32 v34, v89, v62
    v_fmac_f32 v35, v89, v63
    v_fmac_f32 v36, v89, v64
    v_fmac_f32 v37, v89, v65
    v_fmac_f32 v38, v89, v66
    v_fmac_f32 v39, v89, v67
    v_fmac_f32 v40, v89, v68
    v_fmac_f32 v41, v89, v69
    v_fmac_f32 v42, v89, v70
    v_fmac_f32 v43, v89, v71
    v_fmac_f32 v44, v89, v72
    v_fmac_f32 v45, v89, v73
    v_fmac_f32 v46, v89, v74
    v_fmac_f32 v47, v89, v75
    v_fmac_f32 v48, v89, v76
    v_fmac_f32 v49, v89, v77
    v_fmac_f32 v50, v89, v78
    v_fmac_f32 v51, v89, v79
    v_fmac_f32 v52, v89, v80
    v_fmac_f32 v53, v89, v81
    v_fmac_f32 v54, v89, v82
    v_fmac_f32 v55, v89, v83
    v_fmac_f32 v56, v89, v84
    v_fmac_f32 v57, v89, v85
    v_fmac_f32 v58, v89, v86
    v_fmac_f32 v59, v89, v87
    s_waitcnt vmcnt(12)
    v_and_b32 v61, 0xffff0000, v132
    v_lshlrev_b32 v60, 16, v132
    v_and_b32 v63, 0xffff0000, v133
    v_lshlrev_b32 v62, 16, v133
    v_and_b32 v65, 0xffff0000, v134
    v_lshlrev_b32 v64, 16, v134
    v_and_b32 v67, 0xffff0000, v135
    v_lshlrev_b32 v66, 16, v135
    v_and_b32 v69, 0xffff0000, v136
    v_lshlrev_b32 v68, 16, v136
    v_and_b32 v71, 0xffff0000, v137
    v_lshlrev_b32 v70, 16, v137
    v_and_b32 v73, 0xffff0000, v138
    v_lshlrev_b32 v72, 16, v138
    v_and_b32 v75, 0xffff0000, v139
    v_lshlrev_b32 v74, 16, v139
    v_and_b32 v77, 0xffff0000, v140
    v_lshlrev_b32 v76, 16, v140
    v_and_b32 v79, 0xffff0000, v141
    v_lshlrev_b32 v78, 16, v141
    v_and_b32 v81, 0xffff0000, v142
    v_lshlrev_b32 v80, 16, v142
    v_and_b32 v83, 0xffff0000, v143
    v_lshlrev_b32 v82, 16, v143
    v_and_b32 v85, 0xffff0000, v144
    v_lshlrev_b32 v84, 16, v144
    v_and_b32 v87, 0xffff0000, v145
    v_lshlrev_b32 v86, 16, v145
    buffer_load_dwordx4 v[132:135], v14, s[44:47], 0 offen offset:1792
    buffer_load_dwordx4 v[136:139], v14, s[44:47], 0 offen offset:1808
    buffer_load_dwordx4 v[140:143], v14, s[44:47], 0 offen offset:1824
    buffer_load_dwordx2 v[144:145], v14, s[44:47], 0 offen offset:1840
    v_fmac_f32 v32, v90, v60
    v_fmac_f32 v33, v90, v61
    v_fmac_f32 v34, v90, v62
    v_fmac_f32 v35, v90, v63
    v_fmac_f32 v36, v90, v64
    v_fmac_f32 v37, v90, v65
    v_fmac_f32 v38, v90, v66
    v_fmac_f32 v39, v90, v67
    v_fmac_f32 v40, v90, v68
    v_fmac_f32 v41, v90, v69
    v_fmac_f32 v42, v90, v70
    v_fmac_f32 v43, v90, v71
    v_fmac_f32 v44, v90, v72
    v_fmac_f32 v45, v90, v73
    v_fmac_f32 v46, v90, v74
    v_fmac_f32 v47, v90, v75
    v_fmac_f32 v48, v90, v76
    v_fmac_f32 v49, v90, v77
    v_fmac_f32 v50, v90, v78
    v_fmac_f32 v51, v90, v79
    v_fmac_f32 v52, v90, v80
    v_fmac_f32 v53, v90, v81
    v_fmac_f32 v54, v90, v82
    v_fmac_f32 v55, v90, v83
    v_fmac_f32 v56, v90, v84
    v_fmac_f32 v57, v90, v85
    v_fmac_f32 v58, v90, v86
    v_fmac_f32 v59, v90, v87
    s_waitcnt vmcnt(12)
    v_and_b32 v61, 0xffff0000, v148
    v_lshlrev_b32 v60, 16, v148
    v_and_b32 v63, 0xffff0000, v149
    v_lshlrev_b32 v62, 16, v149
    v_and_b32 v65, 0xffff0000, v150
    v_lshlrev_b32 v64, 16, v150
    v_and_b32 v67, 0xffff0000, v151
    v_lshlrev_b32 v66, 16, v151
    v_and_b32 v69, 0xffff0000, v152
    v_lshlrev_b32 v68, 16, v152
    v_and_b32 v71, 0xffff0000, v153
    v_lshlrev_b32 v70, 16, v153
    v_and_b32 v73, 0xffff0000, v154
    v_lshlrev_b32 v72, 16, v154
    v_and_b32 v75, 0xffff0000, v155
    v_lshlrev_b32 v74, 16, v155
    v_and_b32 v77, 0xffff0000, v156
    v_lshlrev_b32 v76, 16, v156
    v_and_b32 v79, 0xffff0000, v157
    v_lshlrev_b32 v78, 16, v157
    v_and_b32 v81, 0xffff0000, v158
    v_lshlrev_b32 v80, 16, v158
    v_and_b32 v83, 0xffff0000, v159
    v_lshlrev_b32 v82, 16, v159
    v_and_b32 v85, 0xffff0000, v160
    v_lshlrev_b32 v84, 16, v160
    v_and_b32 v87, 0xffff0000, v161
    v_lshlrev_b32 v86, 16, v161
    buffer_load_dwordx4 v[148:151], v15, s[44:47], 0 offen offset:1792
    buffer_load_dwordx4 v[152:155], v15, s[44:47], 0 offen offset:1808
    buffer_load_dwordx4 v[156:159], v15, s[44:47], 0 offen offset:1824
    buffer_load_dwordx2 v[160:161], v15, s[44:47], 0 offen offset:1840
    v_fmac_f32 v32, v91, v60
    v_fmac_f32 v33, v91, v61
    v_fmac_f32 v34, v91, v62
    v_fmac_f32 v35, v91, v63
    v_fmac_f32 v36, v91, v64
    v_fmac_f32 v37, v91, v65
    v_fmac_f32 v38, v91, v66
    v_fmac_f32 v39, v91, v67
    v_fmac_f32 v40, v91, v68
    v_fmac_f32 v41, v91, v69
    v_fmac_f32 v42, v91, v70
    v_fmac_f32 v43, v91, v71
    v_fmac_f32 v44, v91, v72
    v_fmac_f32 v45, v91, v73
    v_fmac_f32 v46, v91, v74
    v_fmac_f32 v47, v91, v75
    v_fmac_f32 v48, v91, v76
    v_fmac_f32 v49, v91, v77
    v_fmac_f32 v50, v91, v78
    v_fmac_f32 v51, v91, v79
    v_fmac_f32 v52, v91, v80
    v_fmac_f32 v53, v91, v81
    v_fmac_f32 v54, v91, v82
    v_fmac_f32 v55, v91, v83
    v_fmac_f32 v56, v91, v84
    v_fmac_f32 v57, v91, v85
    v_fmac_f32 v58, v91, v86
    v_fmac_f32 v59, v91, v87
    s_waitcnt vmcnt(12)
    v_and_b32 v61, 0xffff0000, v100
    v_lshlrev_b32 v60, 16, v100
    v_and_b32 v63, 0xffff0000, v101
    v_lshlrev_b32 v62, 16, v101
    v_and_b32 v65, 0xffff0000, v102
    v_lshlrev_b32 v64, 16, v102
    v_and_b32 v67, 0xffff0000, v103
    v_lshlrev_b32 v66, 16, v103
    v_and_b32 v69, 0xffff0000, v104
    v_lshlrev_b32 v68, 16, v104
    v_and_b32 v71, 0xffff0000, v105
    v_lshlrev_b32 v70, 16, v105
    v_and_b32 v73, 0xffff0000, v106
    v_lshlrev_b32 v72, 16, v106
    v_and_b32 v75, 0xffff0000, v107
    v_lshlrev_b32 v74, 16, v107
    v_and_b32 v77, 0xffff0000, v108
    v_lshlrev_b32 v76, 16, v108
    v_and_b32 v79, 0xffff0000, v109
    v_lshlrev_b32 v78, 16, v109
    v_and_b32 v81, 0xffff0000, v110
    v_lshlrev_b32 v80, 16, v110
    v_and_b32 v83, 0xffff0000, v111
    v_lshlrev_b32 v82, 16, v111
    v_and_b32 v85, 0xffff0000, v112
    v_lshlrev_b32 v84, 16, v112
    v_and_b32 v87, 0xffff0000, v113
    v_lshlrev_b32 v86, 16, v113
    v_fmac_f32 v32, v92, v60
    v_fmac_f32 v33, v92, v61
    v_fmac_f32 v34, v92, v62
    v_fmac_f32 v35, v92, v63
    v_fmac_f32 v36, v92, v64
    v_fmac_f32 v37, v92, v65
    v_fmac_f32 v38, v92, v66
    v_fmac_f32 v39, v92, v67
    v_fmac_f32 v40, v92, v68
    v_fmac_f32 v41, v92, v69
    v_fmac_f32 v42, v92, v70
    v_fmac_f32 v43, v92, v71
    v_fmac_f32 v44, v92, v72
    v_fmac_f32 v45, v92, v73
    v_fmac_f32 v46, v92, v74
    v_fmac_f32 v47, v92, v75
    v_fmac_f32 v48, v92, v76
    v_fmac_f32 v49, v92, v77
    v_fmac_f32 v50, v92, v78
    v_fmac_f32 v51, v92, v79
    v_fmac_f32 v52, v92, v80
    v_fmac_f32 v53, v92, v81
    v_fmac_f32 v54, v92, v82
    v_fmac_f32 v55, v92, v83
    v_fmac_f32 v56, v92, v84
    v_fmac_f32 v57, v92, v85
    v_fmac_f32 v58, v92, v86
    v_fmac_f32 v59, v92, v87
    s_waitcnt vmcnt(8)
    v_and_b32 v61, 0xffff0000, v116
    v_lshlrev_b32 v60, 16, v116
    v_and_b32 v63, 0xffff0000, v117
    v_lshlrev_b32 v62, 16, v117
    v_and_b32 v65, 0xffff0000, v118
    v_lshlrev_b32 v64, 16, v118
    v_and_b32 v67, 0xffff0000, v119
    v_lshlrev_b32 v66, 16, v119
    v_and_b32 v69, 0xffff0000, v120
    v_lshlrev_b32 v68, 16, v120
    v_and_b32 v71, 0xffff0000, v121
    v_lshlrev_b32 v70, 16, v121
    v_and_b32 v73, 0xffff0000, v122
    v_lshlrev_b32 v72, 16, v122
    v_and_b32 v75, 0xffff0000, v123
    v_lshlrev_b32 v74, 16, v123
    v_and_b32 v77, 0xffff0000, v124
    v_lshlrev_b32 v76, 16, v124
    v_and_b32 v79, 0xffff0000, v125
    v_lshlrev_b32 v78, 16, v125
    v_and_b32 v81, 0xffff0000, v126
    v_lshlrev_b32 v80, 16, v126
    v_and_b32 v83, 0xffff0000, v127
    v_lshlrev_b32 v82, 16, v127
    v_and_b32 v85, 0xffff0000, v128
    v_lshlrev_b32 v84, 16, v128
    v_and_b32 v87, 0xffff0000, v129
    v_lshlrev_b32 v86, 16, v129
    v_fmac_f32 v32, v93, v60
    v_fmac_f32 v33, v93, v61
    v_fmac_f32 v34, v93, v62
    v_fmac_f32 v35, v93, v63
    v_fmac_f32 v36, v93, v64
    v_fmac_f32 v37, v93, v65
    v_fmac_f32 v38, v93, v66
    v_fmac_f32 v39, v93, v67
    v_fmac_f32 v40, v93, v68
    v_fmac_f32 v41, v93, v69
    v_fmac_f32 v42, v93, v70
    v_fmac_f32 v43, v93, v71
    v_fmac_f32 v44, v93, v72
    v_fmac_f32 v45, v93, v73
    v_fmac_f32 v46, v93, v74
    v_fmac_f32 v47, v93, v75
    v_fmac_f32 v48, v93, v76
    v_fmac_f32 v49, v93, v77
    v_fmac_f32 v50, v93, v78
    v_fmac_f32 v51, v93, v79
    v_fmac_f32 v52, v93, v80
    v_fmac_f32 v53, v93, v81
    v_fmac_f32 v54, v93, v82
    v_fmac_f32 v55, v93, v83
    v_fmac_f32 v56, v93, v84
    v_fmac_f32 v57, v93, v85
    v_fmac_f32 v58, v93, v86
    v_fmac_f32 v59, v93, v87
    s_waitcnt vmcnt(4)
    v_and_b32 v61, 0xffff0000, v132
    v_lshlrev_b32 v60, 16, v132
    v_and_b32 v63, 0xffff0000, v133
    v_lshlrev_b32 v62, 16, v133
    v_and_b32 v65, 0xffff0000, v134
    v_lshlrev_b32 v64, 16, v134
    v_and_b32 v67, 0xffff0000, v135
    v_lshlrev_b32 v66, 16, v135
    v_and_b32 v69, 0xffff0000, v136
    v_lshlrev_b32 v68, 16, v136
    v_and_b32 v71, 0xffff0000, v137
    v_lshlrev_b32 v70, 16, v137
    v_and_b32 v73, 0xffff0000, v138
    v_lshlrev_b32 v72, 16, v138
    v_and_b32 v75, 0xffff0000, v139
    v_lshlrev_b32 v74, 16, v139
    v_and_b32 v77, 0xffff0000, v140
    v_lshlrev_b32 v76, 16, v140
    v_and_b32 v79, 0xffff0000, v141
    v_lshlrev_b32 v78, 16, v141
    v_and_b32 v81, 0xffff0000, v142
    v_lshlrev_b32 v80, 16, v142
    v_and_b32 v83, 0xffff0000, v143
    v_lshlrev_b32 v82, 16, v143
    v_and_b32 v85, 0xffff0000, v144
    v_lshlrev_b32 v84, 16, v144
    v_and_b32 v87, 0xffff0000, v145
    v_lshlrev_b32 v86, 16, v145
    v_fmac_f32 v32, v94, v60
    v_fmac_f32 v33, v94, v61
    v_fmac_f32 v34, v94, v62
    v_fmac_f32 v35, v94, v63
    v_fmac_f32 v36, v94, v64
    v_fmac_f32 v37, v94, v65
    v_fmac_f32 v38, v94, v66
    v_fmac_f32 v39, v94, v67
    v_fmac_f32 v40, v94, v68
    v_fmac_f32 v41, v94, v69
    v_fmac_f32 v42, v94, v70
    v_fmac_f32 v43, v94, v71
    v_fmac_f32 v44, v94, v72
    v_fmac_f32 v45, v94, v73
    v_fmac_f32 v46, v94, v74
    v_fmac_f32 v47, v94, v75
    v_fmac_f32 v48, v94, v76
    v_fmac_f32 v49, v94, v77
    v_fmac_f32 v50, v94, v78
    v_fmac_f32 v51, v94, v79
    v_fmac_f32 v52, v94, v80
    v_fmac_f32 v53, v94, v81
    v_fmac_f32 v54, v94, v82
    v_fmac_f32 v55, v94, v83
    v_fmac_f32 v56, v94, v84
    v_fmac_f32 v57, v94, v85
    v_fmac_f32 v58, v94, v86
    v_fmac_f32 v59, v94, v87
    s_waitcnt vmcnt(0)
    v_and_b32 v61, 0xffff0000, v148
    v_lshlrev_b32 v60, 16, v148
    v_and_b32 v63, 0xffff0000, v149
    v_lshlrev_b32 v62, 16, v149
    v_and_b32 v65, 0xffff0000, v150
    v_lshlrev_b32 v64, 16, v150
    v_and_b32 v67, 0xffff0000, v151
    v_lshlrev_b32 v66, 16, v151
    v_and_b32 v69, 0xffff0000, v152
    v_lshlrev_b32 v68, 16, v152
    v_and_b32 v71, 0xffff0000, v153
    v_lshlrev_b32 v70, 16, v153
    v_and_b32 v73, 0xffff0000, v154
    v_lshlrev_b32 v72, 16, v154
    v_and_b32 v75, 0xffff0000, v155
    v_lshlrev_b32 v74, 16, v155
    v_and_b32 v77, 0xffff0000, v156
    v_lshlrev_b32 v76, 16, v156
    v_and_b32 v79, 0xffff0000, v157
    v_lshlrev_b32 v78, 16, v157
    v_and_b32 v81, 0xffff0000, v158
    v_lshlrev_b32 v80, 16, v158
    v_and_b32 v83, 0xffff0000, v159
    v_lshlrev_b32 v82, 16, v159
    v_and_b32 v85, 0xffff0000, v160
    v_lshlrev_b32 v84, 16, v160
    v_and_b32 v87, 0xffff0000, v161
    v_lshlrev_b32 v86, 16, v161
    v_fmac_f32 v32, v95, v60
    v_fmac_f32 v33, v95, v61
    v_fmac_f32 v34, v95, v62
    v_fmac_f32 v35, v95, v63
    v_fmac_f32 v36, v95, v64
    v_fmac_f32 v37, v95, v65
    v_fmac_f32 v38, v95, v66
    v_fmac_f32 v39, v95, v67
    v_fmac_f32 v40, v95, v68
    v_fmac_f32 v41, v95, v69
    v_fmac_f32 v42, v95, v70
    v_fmac_f32 v43, v95, v71
    v_fmac_f32 v44, v95, v72
    v_fmac_f32 v45, v95, v73
    v_fmac_f32 v46, v95, v74
    v_fmac_f32 v47, v95, v75
    v_fmac_f32 v48, v95, v76
    v_fmac_f32 v49, v95, v77
    v_fmac_f32 v50, v95, v78
    v_fmac_f32 v51, v95, v79
    v_fmac_f32 v52, v95, v80
    v_fmac_f32 v53, v95, v81
    v_fmac_f32 v54, v95, v82
    v_fmac_f32 v55, v95, v83
    v_fmac_f32 v56, v95, v84
    v_fmac_f32 v57, v95, v85
    v_fmac_f32 v58, v95, v86
    v_fmac_f32 v59, v95, v87
    v_mul_f32 v32, v5, v32
    v_mul_f32 v33, v5, v33
    v_mul_f32 v34, v5, v34
    v_mul_f32 v35, v5, v35
    v_mul_f32 v36, v5, v36
    v_mul_f32 v37, v5, v37
    v_mul_f32 v38, v5, v38
    v_mul_f32 v39, v5, v39
    v_mul_f32 v40, v5, v40
    v_mul_f32 v41, v5, v41
    v_mul_f32 v42, v5, v42
    v_mul_f32 v43, v5, v43
    v_mul_f32 v44, v5, v44
    v_mul_f32 v45, v5, v45
    v_mul_f32 v46, v5, v46
    v_mul_f32 v47, v5, v47
    v_mul_f32 v48, v5, v48
    v_mul_f32 v49, v5, v49
    v_mul_f32 v50, v5, v50
    v_mul_f32 v51, v5, v51
    v_mul_f32 v52, v5, v52
    v_mul_f32 v53, v5, v53
    v_mul_f32 v54, v5, v54
    v_mul_f32 v55, v5, v55
    v_mul_f32 v56, v5, v56
    v_mul_f32 v57, v5, v57
    v_mul_f32 v58, v5, v58
    v_mul_f32 v59, v5, v59
    v_cvt_pk_bf16_f32 v16, v32, v33
    v_cvt_pk_bf16_f32 v17, v34, v35
    v_cvt_pk_bf16_f32 v18, v36, v37
    v_cvt_pk_bf16_f32 v19, v38, v39
    v_cvt_pk_bf16_f32 v20, v40, v41
    v_cvt_pk_bf16_f32 v21, v42, v43
    v_cvt_pk_bf16_f32 v22, v44, v45
    v_cvt_pk_bf16_f32 v23, v46, v47
    v_cvt_pk_bf16_f32 v24, v48, v49
    v_cvt_pk_bf16_f32 v25, v50, v51
    v_cvt_pk_bf16_f32 v26, v52, v53
    v_cvt_pk_bf16_f32 v27, v54, v55
    v_cvt_pk_bf16_f32 v28, v56, v57
    v_cvt_pk_bf16_f32 v29, v58, v59
    v_mul_u32_u24 v4, 896, v2
    v_add_u32 v4, v4, v3
    v_add_u32 v4, 11534336, v4
    buffer_store_dwordx4 v[16:19], v4, s[44:47], 0 offen offset:0
    buffer_store_dwordx4 v[20:23], v4, s[44:47], 0 offen offset:16
    buffer_store_dwordx4 v[24:27], v4, s[44:47], 0 offen offset:32
    buffer_store_dwordx2 v[28:29], v4, s[44:47], 0 offen offset:48
K2_END:
    s_endpgm
.p2align 8
.globl k3_kernel
.type k3_kernel,@function
k3_kernel:
    s_cmp_ge_u32 s2, 224
    s_cbranch_scc1 K3_END
    s_load_dwordx2 s[4:5], s[0:1], 32
    s_load_dwordx4 s[8:11], s[0:1], 56
    s_load_dwordx2 s[16:17], s[0:1], 80
    s_and_b32 s39, s2, 15
    s_lshr_b32 s3, s2, 4
    s_mul_i32 s32, s39, 114688
    s_lshl_b32 s39, s39, 7
    v_and_b32 v1, 63, v0
    v_lshrrev_b32 v2, 6, v0
    s_nop 0
    v_readfirstlane_b32 s35, v2
    s_and_b32 s36, s35, 1
    s_lshr_b32 s37, s35, 1
    s_waitcnt lgkmcnt(0)
    s_mov_b32 s24, s16
    s_and_b32 s25, s17, 0xffff
    s_mov_b32 s26, 268435456
    s_mov_b32 s27, 0x20000
    s_mov_b32 s44, s10
    s_and_b32 s45, s11, 0xffff
    s_mov_b32 s46, 3670016
    s_mov_b32 s47, 0x20000
    s_cmp_ge_u32 s3, 7
    s_cselect_b32 s6, s8, s4
    s_cselect_b32 s7, s9, s5
    s_cselect_b32 s35, 2097152, 0
    s_cselect_b32 s41, 7, 0
    s_cselect_b32 s40, 896, 0
    s_add_u32 s32, s32, s35
    s_add_u32 s32, s32, 9437184
    s_sub_u32 s3, s3, s41
    s_mov_b32 s28, s6
    s_and_b32 s29, s7, 0xffff
    s_mov_b32 s30, 401408
    s_mov_b32 s31, 0x20000
    s_mov_b32 s33, 896
    s_lshl_b32 s34, s3, 7
    v_lshrrev_b32 v12, 3, v0
    v_and_b32 v13, 7, v0
    v_mul_u32_u24 v2, 896, v12
    v_lshl_add_u32 v2, v13, 4, v2
    v_add_u32 v2, s32, v2
    v_add_u32 v3, 28672, v2
    v_add_u32 v4, 57344, v2
    v_add_u32 v5, 86016, v2
    v_mul_u32_u24 v10, 144, v12
    v_lshl_add_u32 v10, v13, 4, v10
    v_lshrrev_b32 v12, 3, v0
    v_and_b32 v13, 7, v0
    v_mul_lo_u32 v6, s33, v12
    v_lshl_add_u32 v6, v13, 4, v6
    v_add_u32 v6, s34, v6
    s_mul_i32 s35, s33, 32
    v_add_u32 v7, s35, v6
    v_mul_u32_u24 v11, 320, v12
    v_lshl_add_u32 v11, v13, 4, v11
    v_add_u32 v11, 18432, v11
    v_and_b32 v12, 31, v1
    v_lshrrev_b32 v13, 5, v1
    s_lshl_b32 s35, s36, 6
    v_add_u32 v12, s35, v12
    v_mul_u32_u24 v52, 144, v12
    v_lshl_add_u32 v52, v13, 4, v52
    v_bfe_u32 v12, v1, 2, 2
    v_lshl_add_u32 v12, v13, 3, v12
    v_mul_u32_u24 v53, 320, v12
    v_bfe_u32 v12, v1, 4, 1
    v_and_b32 v13, 3, v1
    v_lshlrev_b32 v12, 5, v12
    v_lshl_add_u32 v12, v13, 3, v12
    v_add_u32 v53, v53, v12
    s_mul_i32 s35, s37, 64
    v_add_u32 v53, s35, v53
    v_add_u32 v53, 18432, v53
    v_mov_b32 v64, 0
    v_mov_b32 v65, 0
    v_mov_b32 v66, 0
    v_mov_b32 v67, 0
    v_mov_b32 v68, 0
    v_mov_b32 v69, 0
    v_mov_b32 v70, 0
    v_mov_b32 v71, 0
    v_mov_b32 v72, 0
    v_mov_b32 v73, 0
    v_mov_b32 v74, 0
    v_mov_b32 v75, 0
    v_mov_b32 v76, 0
    v_mov_b32 v77, 0
    v_mov_b32 v78, 0
    v_mov_b32 v79, 0
    v_mov_b32 v80, 0
    v_mov_b32 v81, 0
    v_mov_b32 v82, 0
    v_mov_b32 v83, 0
    v_mov_b32 v84, 0
    v_mov_b32 v85, 0
    v_mov_b32 v86, 0
    v_mov_b32 v87, 0
    v_mov_b32 v88, 0
    v_mov_b32 v89, 0
    v_mov_b32 v90, 0
    v_mov_b32 v91, 0
    v_mov_b32 v92, 0
    v_mov_b32 v93, 0
    v_mov_b32 v94, 0
    v_mov_b32 v95, 0
    s_mov_b32 s38, 0
    buffer_load_dwordx4 v[16:19], v2, s[24:27], s38 offen
    buffer_load_dwordx4 v[20:23], v3, s[24:27], s38 offen
    buffer_load_dwordx4 v[24:27], v4, s[24:27], s38 offen
    buffer_load_dwordx4 v[28:31], v5, s[24:27], s38 offen
    s_mul_i32 s38, s33, 0
    buffer_load_dwordx4 v[32:35], v6, s[28:31], s38 offen
    buffer_load_dwordx4 v[36:39], v7, s[28:31], s38 offen
    s_mov_b32 s38, 128
    buffer_load_dwordx4 v[144:147], v2, s[24:27], s38 offen
    buffer_load_dwordx4 v[148:151], v3, s[24:27], s38 offen
    buffer_load_dwordx4 v[152:155], v4, s[24:27], s38 offen
    buffer_load_dwordx4 v[156:159], v5, s[24:27], s38 offen
    s_mul_i32 s38, s33, 64
    buffer_load_dwordx4 v[160:163], v6, s[28:31], s38 offen
    buffer_load_dwordx4 v[164:167], v7, s[28:31], s38 offen
    s_waitcnt vmcnt(6)
    ds_write_b128 v10, v[16:19] offset:0
    ds_write_b128 v10, v[20:23] offset:4608
    ds_write_b128 v10, v[24:27] offset:9216
    ds_write_b128 v10, v[28:31] offset:13824
    ds_write_b128 v11, v[32:35] offset:0
    ds_write_b128 v11, v[36:39] offset:10240
    s_waitcnt lgkmcnt(0)
    s_barrier
    s_mov_b32 s38, 256
    buffer_load_dwordx4 v[16:19], v2, s[24:27], s38 offen
    buffer_load_dwordx4 v[20:23], v3, s[24:27], s38 offen
    buffer_load_dwordx4 v[24:27], v4, s[24:27], s38 offen
    buffer_load_dwordx4 v[28:31], v5, s[24:27], s38 offen
    s_mul_i32 s38, s33, 128
    buffer_load_dwordx4 v[32:35], v6, s[28:31], s38 offen
    buffer_load_dwordx4 v[36:39], v7, s[28:31], s38 offen
    ds_read_b128 v[128:131], v52 offset:0
    ds_read_b128 v[132:135], v52 offset:4608
    ds_read_b64_tr_b16 v[136:137], v53 offset:0
    ds_read_b64_tr_b16 v[138:139], v53 offset:1280
    s_waitcnt lgkmcnt(0)
    v_mfma_f32_32x32x16_bf16 v[64:79], v[136:139], v[128:131], v[64:79]
    v_mfma_f32_32x32x16_bf16 v[80:95], v[136:139], v[132:135], v[80:95]
    ds_read_b128 v[128:131], v52 offset:32
    ds_read_b128 v[132:135], v52 offset:4640
    ds_read_b64_tr_b16 v[136:137], v53 offset:5120
    ds_read_b64_tr_b16 v[138:139], v53 offset:6400
    s_waitcnt lgkmcnt(0)
    v_mfma_f32_32x32x16_bf16 v[64:79], v[136:139], v[128:131], v[64:79]
    v_mfma_f32_32x32x16_bf16 v[80:95], v[136:139], v[132:135], v[80:95]
    ds_read_b128 v[128:131], v52 offset:64
    ds_read_b128 v[132:135], v52 offset:4672
    ds_read_b64_tr_b16 v[136:137], v53 offset:10240
    ds_read_b64_tr_b16 v[138:139], v53 offset:11520
    s_waitcnt lgkmcnt(0)
    v_mfma_f32_32x32x16_bf16 v[64:79], v[136:139], v[128:131], v[64:79]
    v_mfma_f32_32x32x16_bf16 v[80:95], v[136:139], v[132:135], v[80:95]
    ds_read_b128 v[128:131], v52 offset:96
    ds_read_b128 v[132:135], v52 offset:4704
    ds_read_b64_tr_b16 v[136:137], v53 offset:15360
    ds_read_b64_tr_b16 v[138:139], v53 offset:16640
    s_waitcnt lgkmcnt(0)
    v_mfma_f32_32x32x16_bf16 v[64:79], v[136:139], v[128:131], v[64:79]
    v_mfma_f32_32x32x16_bf16 v[80:95], v[136:139], v[132:135], v[80:95]
    s_waitcnt vmcnt(6)
    ds_write_b128 v10, v[144:147] offset:38912
    ds_write_b128 v10, v[148:151] offset:43520
    ds_write_b128 v10, v[152:155] offset:48128
    ds_write_b128 v10, v[156:159] offset:52736
    ds_write_b128 v11, v[160:163] offset:38912
    ds_write_b128 v11, v[164:167] offset:49152
    s_waitcnt lgkmcnt(0)
    s_barrier
    s_mov_b32 s38, 384
    buffer_load_dwordx4 v[144:147], v2, s[24:27], s38 offen
    buffer_load_dwordx4 v[148:151], v3, s[24:27], s38 offen
    buffer_load_dwordx4 v[152:155], v4, s[24:27], s38 offen
    buffer_load_dwordx4 v[156:159], v5, s[24:27], s38 offen
    s_mul_i32 s38, s33, 192
    buffer_load_dwordx4 v[160:163], v6, s[28:31], s38 offen
    buffer_load_dwordx4 v[164:167], v7, s[28:31], s38 offen
    ds_read_b128 v[128:131], v52 offset:38912
    ds_read_b128 v[132:135], v52 offset:43520
    ds_read_b64_tr_b16 v[136:137], v53 offset:38912
    ds_read_b64_tr_b16 v[138:139], v53 offset:40192
    s_waitcnt lgkmcnt(0)
    v_mfma_f32_32x32x16_bf16 v[64:79], v[136:139], v[128:131], v[64:79]
    v_mfma_f32_32x32x16_bf16 v[80:95], v[136:139], v[132:135], v[80:95]
    ds_read_b128 v[128:131], v52 offset:38944
    ds_read_b128 v[132:135], v52 offset:43552
    ds_read_b64_tr_b16 v[136:137], v53 offset:44032
    ds_read_b64_tr_b16 v[138:139], v53 offset:45312
    s_waitcnt lgkmcnt(0)
    v_mfma_f32_32x32x16_bf16 v[64:79], v[136:139], v[128:131], v[64:79]
    v_mfma_f32_32x32x16_bf16 v[80:95], v[136:139], v[132:135], v[80:95]
    ds_read_b128 v[128:131], v52 offset:38976
    ds_read_b128 v[132:135], v52 offset:43584
    ds_read_b64_tr_b16 v[136:137], v53 offset:49152
    ds_read_b64_tr_b16 v[138:139], v53 offset:50432
    s_waitcnt lgkmcnt(0)
    v_mfma_f32_32x32x16_bf16 v[64:79], v[136:139], v[128:131], v[64:79]
    v_mfma_f32_32x32x16_bf16 v[80:95], v[136:139], v[132:135], v[80:95]
    ds_read_b128 v[128:131], v52 offset:39008
    ds_read_b128 v[132:135], v52 offset:43616
    ds_read_b64_tr_b16 v[136:137], v53 offset:54272
    ds_read_b64_tr_b16 v[138:139], v53 offset:55552
    s_waitcnt lgkmcnt(0)
    v_mfma_f32_32x32x16_bf16 v[64:79], v[136:139], v[128:131], v[64:79]
    v_mfma_f32_32x32x16_bf16 v[80:95], v[136:139], v[132:135], v[80:95]
    s_waitcnt vmcnt(6)
    ds_write_b128 v10, v[16:19] offset:0
    ds_write_b128 v10, v[20:23] offset:4608
    ds_write_b128 v10, v[24:27] offset:9216
    ds_write_b128 v10, v[28:31] offset:13824
    ds_write_b128 v11, v[32:35] offset:0
    ds_write_b128 v11, v[36:39] offset:10240
    s_waitcnt lgkmcnt(0)
    s_barrier
    s_mov_b32 s38, 512
    buffer_load_dwordx4 v[16:19], v2, s[24:27], s38 offen
    buffer_load_dwordx4 v[20:23], v3, s[24:27], s38 offen
    buffer_load_dwordx4 v[24:27], v4, s[24:27], s38 offen
    buffer_load_dwordx4 v[28:31], v5, s[24:27], s38 offen
    s_mul_i32 s38, s33, 256
    buffer_load_dwordx4 v[32:35], v6, s[28:31], s38 offen
    buffer_load_dwordx4 v[36:39], v7, s[28:31], s38 offen
    ds_read_b128 v[128:131], v52 offset:0
    ds_read_b128 v[132:135], v52 offset:4608
    ds_read_b64_tr_b16 v[136:137], v53 offset:0
    ds_read_b64_tr_b16 v[138:139], v53 offset:1280
    s_waitcnt lgkmcnt(0)
    v_mfma_f32_32x32x16_bf16 v[64:79], v[136:139], v[128:131], v[64:79]
    v_mfma_f32_32x32x16_bf16 v[80:95], v[136:139], v[132:135], v[80:95]
    ds_read_b128 v[128:131], v52 offset:32
    ds_read_b128 v[132:135], v52 offset:4640
    ds_read_b64_tr_b16 v[136:137], v53 offset:5120
    ds_read_b64_tr_b16 v[138:139], v53 offset:6400
    s_waitcnt lgkmcnt(0)
    v_mfma_f32_32x32x16_bf16 v[64:79], v[136:139], v[128:131], v[64:79]
    v_mfma_f32_32x32x16_bf16 v[80:95], v[136:139], v[132:135], v[80:95]
    ds_read_b128 v[128:131], v52 offset:64
    ds_read_b128 v[132:135], v52 offset:4672
    ds_read_b64_tr_b16 v[136:137], v53 offset:10240
    ds_read_b64_tr_b16 v[138:139], v53 offset:11520
    s_waitcnt lgkmcnt(0)
    v_mfma_f32_32x32x16_bf16 v[64:79], v[136:139], v[128:131], v[64:79]
    v_mfma_f32_32x32x16_bf16 v[80:95], v[136:139], v[132:135], v[80:95]
    ds_read_b128 v[128:131], v52 offset:96
    ds_read_b128 v[132:135], v52 offset:4704
    ds_read_b64_tr_b16 v[136:137], v53 offset:15360
    ds_read_b64_tr_b16 v[138:139], v53 offset:16640
    s_waitcnt lgkmcnt(0)
    v_mfma_f32_32x32x16_bf16 v[64:79], v[136:139], v[128:131], v[64:79]
    v_mfma_f32_32x32x16_bf16 v[80:95], v[136:139], v[132:135], v[80:95]
    s_waitcnt vmcnt(6)
    ds_write_b128 v10, v[144:147] offset:38912
    ds_write_b128 v10, v[148:151] offset:43520
    ds_write_b128 v10, v[152:155] offset:48128
    ds_write_b128 v10, v[156:159] offset:52736
    ds_write_b128 v11, v[160:163] offset:38912
    ds_write_b128 v11, v[164:167] offset:49152
    s_waitcnt lgkmcnt(0)
    s_barrier
    s_mov_b32 s38, 640
    buffer_load_dwordx4 v[144:147], v2, s[24:27], s38 offen
    buffer_load_dwordx4 v[148:151], v3, s[24:27], s38 offen
    buffer_load_dwordx4 v[152:155], v4, s[24:27], s38 offen
    buffer_load_dwordx4 v[156:159], v5, s[24:27], s38 offen
    s_mul_i32 s38, s33, 320
    buffer_load_dwordx4 v[160:163], v6, s[28:31], s38 offen
    buffer_load_dwordx4 v[164:167], v7, s[28:31], s38 offen
    ds_read_b128 v[128:131], v52 offset:38912
    ds_read_b128 v[132:135], v52 offset:43520
    ds_read_b64_tr_b16 v[136:137], v53 offset:38912
    ds_read_b64_tr_b16 v[138:139], v53 offset:40192
    s_waitcnt lgkmcnt(0)
    v_mfma_f32_32x32x16_bf16 v[64:79], v[136:139], v[128:131], v[64:79]
    v_mfma_f32_32x32x16_bf16 v[80:95], v[136:139], v[132:135], v[80:95]
    ds_read_b128 v[128:131], v52 offset:38944
    ds_read_b128 v[132:135], v52 offset:43552
    ds_read_b64_tr_b16 v[136:137], v53 offset:44032
    ds_read_b64_tr_b16 v[138:139], v53 offset:45312
    s_waitcnt lgkmcnt(0)
    v_mfma_f32_32x32x16_bf16 v[64:79], v[136:139], v[128:131], v[64:79]
    v_mfma_f32_32x32x16_bf16 v[80:95], v[136:139], v[132:135], v[80:95]
    ds_read_b128 v[128:131], v52 offset:38976
    ds_read_b128 v[132:135], v52 offset:43584
    ds_read_b64_tr_b16 v[136:137], v53 offset:49152
    ds_read_b64_tr_b16 v[138:139], v53 offset:50432
    s_waitcnt lgkmcnt(0)
    v_mfma_f32_32x32x16_bf16 v[64:79], v[136:139], v[128:131], v[64:79]
    v_mfma_f32_32x32x16_bf16 v[80:95], v[136:139], v[132:135], v[80:95]
    ds_read_b128 v[128:131], v52 offset:39008
    ds_read_b128 v[132:135], v52 offset:43616
    ds_read_b64_tr_b16 v[136:137], v53 offset:54272
    ds_read_b64_tr_b16 v[138:139], v53 offset:55552
    s_waitcnt lgkmcnt(0)
    v_mfma_f32_32x32x16_bf16 v[64:79], v[136:139], v[128:131], v[64:79]
    v_mfma_f32_32x32x16_bf16 v[80:95], v[136:139], v[132:135], v[80:95]
    s_waitcnt vmcnt(6)
    ds_write_b128 v10, v[16:19] offset:0
    ds_write_b128 v10, v[20:23] offset:4608
    ds_write_b128 v10, v[24:27] offset:9216
    ds_write_b128 v10, v[28:31] offset:13824
    ds_write_b128 v11, v[32:35] offset:0
    ds_write_b128 v11, v[36:39] offset:10240
    s_waitcnt lgkmcnt(0)
    s_barrier
    s_mov_b32 s38, 768
    buffer_load_dwordx4 v[16:19], v2, s[24:27], s38 offen
    buffer_load_dwordx4 v[20:23], v3, s[24:27], s38 offen
    buffer_load_dwordx4 v[24:27], v4, s[24:27], s38 offen
    buffer_load_dwordx4 v[28:31], v5, s[24:27], s38 offen
    s_mul_i32 s38, s33, 384
    buffer_load_dwordx4 v[32:35], v6, s[28:31], s38 offen
    buffer_load_dwordx4 v[36:39], v7, s[28:31], s38 offen
    ds_read_b128 v[128:131], v52 offset:0
    ds_read_b128 v[132:135], v52 offset:4608
    ds_read_b64_tr_b16 v[136:137], v53 offset:0
    ds_read_b64_tr_b16 v[138:139], v53 offset:1280
    s_waitcnt lgkmcnt(0)
    v_mfma_f32_32x32x16_bf16 v[64:79], v[136:139], v[128:131], v[64:79]
    v_mfma_f32_32x32x16_bf16 v[80:95], v[136:139], v[132:135], v[80:95]
    ds_read_b128 v[128:131], v52 offset:32
    ds_read_b128 v[132:135], v52 offset:4640
    ds_read_b64_tr_b16 v[136:137], v53 offset:5120
    ds_read_b64_tr_b16 v[138:139], v53 offset:6400
    s_waitcnt lgkmcnt(0)
    v_mfma_f32_32x32x16_bf16 v[64:79], v[136:139], v[128:131], v[64:79]
    v_mfma_f32_32x32x16_bf16 v[80:95], v[136:139], v[132:135], v[80:95]
    ds_read_b128 v[128:131], v52 offset:64
    ds_read_b128 v[132:135], v52 offset:4672
    ds_read_b64_tr_b16 v[136:137], v53 offset:10240
    ds_read_b64_tr_b16 v[138:139], v53 offset:11520
    s_waitcnt lgkmcnt(0)
    v_mfma_f32_32x32x16_bf16 v[64:79], v[136:139], v[128:131], v[64:79]
    v_mfma_f32_32x32x16_bf16 v[80:95], v[136:139], v[132:135], v[80:95]
    ds_read_b128 v[128:131], v52 offset:96
    ds_read_b128 v[132:135], v52 offset:4704
    ds_read_b64_tr_b16 v[136:137], v53 offset:15360
    ds_read_b64_tr_b16 v[138:139], v53 offset:16640
    s_waitcnt lgkmcnt(0)
    v_mfma_f32_32x32x16_bf16 v[64:79], v[136:139], v[128:131], v[64:79]
    v_mfma_f32_32x32x16_bf16 v[80:95], v[136:139], v[132:135], v[80:95]
    s_waitcnt vmcnt(6)
    ds_write_b128 v10, v[144:147] offset:38912
    ds_write_b128 v10, v[148:151] offset:43520
    ds_write_b128 v10, v[152:155] offset:48128
    ds_write_b128 v10, v[156:159] offset:52736
    ds_write_b128 v11, v[160:163] offset:38912
    ds_write_b128 v11, v[164:167] offset:49152
    s_waitcnt lgkmcnt(0)
    s_barrier
    ds_read_b128 v[128:131], v52 offset:38912
    ds_read_b128 v[132:135], v52 offset:43520
    ds_read_b64_tr_b16 v[136:137], v53 offset:38912
    ds_read_b64_tr_b16 v[138:139], v53 offset:40192
    s_waitcnt lgkmcnt(0)
    v_mfma_f32_32x32x16_bf16 v[64:79], v[136:139], v[128:131], v[64:79]
    v_mfma_f32_32x32x16_bf16 v[80:95], v[136:139], v[132:135], v[80:95]
    ds_read_b128 v[128:131], v52 offset:38944
    ds_read_b128 v[132:135], v52 offset:43552
    ds_read_b64_tr_b16 v[136:137], v53 offset:44032
    ds_read_b64_tr_b16 v[138:139], v53 offset:45312
    s_waitcnt lgkmcnt(0)
    v_mfma_f32_32x32x16_bf16 v[64:79], v[136:139], v[128:131], v[64:79]
    v_mfma_f32_32x32x16_bf16 v[80:95], v[136:139], v[132:135], v[80:95]
    ds_read_b128 v[128:131], v52 offset:38976
    ds_read_b128 v[132:135], v52 offset:43584
    ds_read_b64_tr_b16 v[136:137], v53 offset:49152
    ds_read_b64_tr_b16 v[138:139], v53 offset:50432
    s_waitcnt lgkmcnt(0)
    v_mfma_f32_32x32x16_bf16 v[64:79], v[136:139], v[128:131], v[64:79]
    v_mfma_f32_32x32x16_bf16 v[80:95], v[136:139], v[132:135], v[80:95]
    ds_read_b128 v[128:131], v52 offset:39008
    ds_read_b128 v[132:135], v52 offset:43616
    ds_read_b64_tr_b16 v[136:137], v53 offset:54272
    ds_read_b64_tr_b16 v[138:139], v53 offset:55552
    s_waitcnt lgkmcnt(0)
    v_mfma_f32_32x32x16_bf16 v[64:79], v[136:139], v[128:131], v[64:79]
    v_mfma_f32_32x32x16_bf16 v[80:95], v[136:139], v[132:135], v[80:95]
    s_waitcnt vmcnt(0)
    ds_write_b128 v10, v[16:19] offset:0
    ds_write_b128 v10, v[20:23] offset:4608
    ds_write_b128 v10, v[24:27] offset:9216
    ds_write_b128 v10, v[28:31] offset:13824
    ds_write_b128 v11, v[32:35] offset:0
    ds_write_b128 v11, v[36:39] offset:10240
    s_waitcnt lgkmcnt(0)
    s_barrier
    ds_read_b128 v[128:131], v52 offset:0
    ds_read_b128 v[132:135], v52 offset:4608
    ds_read_b64_tr_b16 v[136:137], v53 offset:0
    ds_read_b64_tr_b16 v[138:139], v53 offset:1280
    s_waitcnt lgkmcnt(0)
    v_mfma_f32_32x32x16_bf16 v[64:79], v[136:139], v[128:131], v[64:79]
    v_mfma_f32_32x32x16_bf16 v[80:95], v[136:139], v[132:135], v[80:95]
    ds_read_b128 v[128:131], v52 offset:32
    ds_read_b128 v[132:135], v52 offset:4640
    ds_read_b64_tr_b16 v[136:137], v53 offset:5120
    ds_read_b64_tr_b16 v[138:139], v53 offset:6400
    s_waitcnt lgkmcnt(0)
    v_mfma_f32_32x32x16_bf16 v[64:79], v[136:139], v[128:131], v[64:79]
    v_mfma_f32_32x32x16_bf16 v[80:95], v[136:139], v[132:135], v[80:95]
    ds_read_b128 v[128:131], v52 offset:64
    ds_read_b128 v[132:135], v52 offset:4672
    ds_read_b64_tr_b16 v[136:137], v53 offset:10240
    ds_read_b64_tr_b16 v[138:139], v53 offset:11520
    s_waitcnt lgkmcnt(0)
    v_mfma_f32_32x32x16_bf16 v[64:79], v[136:139], v[128:131], v[64:79]
    v_mfma_f32_32x32x16_bf16 v[80:95], v[136:139], v[132:135], v[80:95]
    ds_read_b128 v[128:131], v52 offset:96
    ds_read_b128 v[132:135], v52 offset:4704
    ds_read_b64_tr_b16 v[136:137], v53 offset:15360
    ds_read_b64_tr_b16 v[138:139], v53 offset:16640
    s_waitcnt lgkmcnt(0)
    v_mfma_f32_32x32x16_bf16 v[64:79], v[136:139], v[128:131], v[64:79]
    v_mfma_f32_32x32x16_bf16 v[80:95], v[136:139], v[132:135], v[80:95]
    s_nop 15
    v_and_b32 v2, 31, v1
    s_lshl_b32 s35, s36, 6
    s_add_u32 s35, s35, s39
    v_add_u32 v2, s35, v2
    v_lshrrev_b32 v3, 5, v1
    v_lshlrev_b32 v3, 2, v3
    s_mul_i32 s35, s37, 32
    v_add_u32 v3, s35, v3
    s_lshl_b32 s35, s3, 6
    v_add_u32 v3, s35, v3
    v_add_u32 v4, 0, v3
    v_add_u32 v13, 0, v2
    v_mul_u32_u24 v14, 1792, v13
    v_lshl_add_u32 v14, v4, 1, v14
    v_add_u32 v14, s40, v14
    v_cvt_pk_bf16_f32 v8, v64, v65
    v_cvt_pk_bf16_f32 v9, v66, v67
    buffer_store_dwordx2 v[8:9], v14, s[44:47], 0 offen
    s_nop 1
    v_add_u32 v13, 32, v2
    v_mul_u32_u24 v14, 1792, v13
    v_lshl_add_u32 v14, v4, 1, v14
    v_add_u32 v14, s40, v14
    v_cvt_pk_bf16_f32 v8, v80, v81
    v_cvt_pk_bf16_f32 v9, v82, v83
    buffer_store_dwordx2 v[8:9], v14, s[44:47], 0 offen
    s_nop 1
    v_add_u32 v4, 8, v3
    v_add_u32 v13, 0, v2
    v_mul_u32_u24 v14, 1792, v13
    v_lshl_add_u32 v14, v4, 1, v14
    v_add_u32 v14, s40, v14
    v_cvt_pk_bf16_f32 v8, v68, v69
    v_cvt_pk_bf16_f32 v9, v70, v71
    buffer_store_dwordx2 v[8:9], v14, s[44:47], 0 offen
    s_nop 1
    v_add_u32 v13, 32, v2
    v_mul_u32_u24 v14, 1792, v13
    v_lshl_add_u32 v14, v4, 1, v14
    v_add_u32 v14, s40, v14
    v_cvt_pk_bf16_f32 v8, v84, v85
    v_cvt_pk_bf16_f32 v9, v86, v87
    buffer_store_dwordx2 v[8:9], v14, s[44:47], 0 offen
    s_nop 1
    v_add_u32 v4, 16, v3
    v_add_u32 v13, 0, v2
    v_mul_u32_u24 v14, 1792, v13
    v_lshl_add_u32 v14, v4, 1, v14
    v_add_u32 v14, s40, v14
    v_cvt_pk_bf16_f32 v8, v72, v73
    v_cvt_pk_bf16_f32 v9, v74, v75
    buffer_store_dwordx2 v[8:9], v14, s[44:47], 0 offen
    s_nop 1
    v_add_u32 v13, 32, v2
    v_mul_u32_u24 v14, 1792, v13
    v_lshl_add_u32 v14, v4, 1, v14
    v_add_u32 v14, s40, v14
    v_cvt_pk_bf16_f32 v8, v88, v89
    v_cvt_pk_bf16_f32 v9, v90, v91
    buffer_store_dwordx2 v[8:9], v14, s[44:47], 0 offen
    s_nop 1
    v_add_u32 v4, 24, v3
    v_add_u32 v13, 0, v2
    v_mul_u32_u24 v14, 1792, v13
    v_lshl_add_u32 v14, v4, 1, v14
    v_add_u32 v14, s40, v14
    v_cvt_pk_bf16_f32 v8, v76, v77
    v_cvt_pk_bf16_f32 v9, v78, v79
    buffer_store_dwordx2 v[8:9], v14, s[44:47], 0 offen
    s_nop 1
    v_add_u32 v13, 32, v2
    v_mul_u32_u24 v14, 1792, v13
    v_lshl_add_u32 v14, v4, 1, v14
    v_add_u32 v14, s40, v14
    v_cvt_pk_bf16_f32 v8, v92, v93
    v_cvt_pk_bf16_f32 v9, v94, v95
    buffer_store_dwordx2 v[8:9], v14, s[44:47], 0 offen
    s_nop 1
K3_END:
    s_endpgm
.section .rodata,"a"
.p2align 6
.amdhsa_kernel k1_kernel
  .amdhsa_next_free_vgpr 176
  .amdhsa_next_free_sgpr 64
  .amdhsa_accum_offset 176
  .amdhsa_group_segment_fixed_size 0
  .amdhsa_kernarg_size 88
  .amdhsa_user_sgpr_count 2
  .amdhsa_user_sgpr_kernarg_segment_ptr 1
  .amdhsa_system_sgpr_workgroup_id_x 1
.end_amdhsa_kernel
.p2align 6
.amdhsa_kernel k2_kernel
  .amdhsa_next_free_vgpr 168
  .amdhsa_next_free_sgpr 64
  .amdhsa_accum_offset 168
  .amdhsa_group_segment_fixed_size 0
  .amdhsa_kernarg_size 88
  .amdhsa_user_sgpr_count 2
  .amdhsa_user_sgpr_kernarg_segment_ptr 1
  .amdhsa_system_sgpr_workgroup_id_x 1
.end_amdhsa_kernel
.p2align 6
.amdhsa_kernel k3_kernel
  .amdhsa_next_free_vgpr 176
  .amdhsa_next_free_sgpr 64
  .amdhsa_accum_offset 176
  .amdhsa_group_segment_fixed_size 0
  .amdhsa_kernarg_size 88
  .amdhsa_user_sgpr_count 2
  .amdhsa_user_sgpr_kernarg_segment_ptr 1
  .amdhsa_system_sgpr_workgroup_id_x 1
.end_amdhsa_kernel
```
